```python
import torch

def _softmax(x, axis=-1):
    return torch.softmax(x, dim=axis)
def _gelu(x):
    return torch.nn.functional.gelu(x, approximate="tanh")
def _silu(x):
    return torch.nn.functional.silu(x)
def _sigmoid(x):
    return torch.sigmoid(x)
def _layernorm(x, axis=-1, eps=1e-5):
    m = x.mean(dim=axis, keepdim=True)
    v = x.var(dim=axis, keepdim=True, unbiased=False)
    return (x - m) / torch.sqrt(v + eps)
def _scatter_add(tgt, idx, src, axis=0):
    return tgt.clone().index_add_(axis, idx, src)
def _segment_sum(src, seg, n):
    out = torch.zeros((n,) + src.shape[1:], dtype=src.dtype)
    return out.index_add_(0, seg, src)
def _pad(x, pw):
    flat = tuple(v for pair in reversed(pw) for v in pair)
    return torch.nn.functional.pad(x, flat)

kernel_name = 'standalone__paged_block_table_kv_pagedattention__sampling'

def setup_inputs():

    _w = (lambda a: (lambda t: t.to(torch.bfloat16) if t.is_floating_point() else t)(torch.as_tensor(a)))
    B, Hq, Hkv, Sq, Skv, D = 32, 32, 4, 1, 2048, 128
    bs = 16
    nbps = max(1, Skv // bs)
    num_phys = B * nbps + 4
    bt = torch.randperm(num_phys)[: B * nbps].reshape(B, nbps).to(torch.int64)
    cl = (nbps * bs - (torch.arange(1, B + 1, dtype=torch.int64) * 2654435761) % max(1, nbps * bs // 2)).to(torch.int64)
    return {
        "q": _w((lambda *s: torch.randn(*s, dtype=torch.bfloat16) * 0.8)(B, Hq, Sq, D)),
        "k_cache": _w((lambda *s: torch.randn(*s, dtype=torch.bfloat16) * 0.8)(num_phys, bs, Hkv, D)),
        "v_cache": _w((lambda *s: torch.randn(*s, dtype=torch.bfloat16) * 0.05)(num_phys, bs, Hkv, D)),
        "block_table": _w(bt),
        "context_lens": _w(cl),
    }

def reference(q, k_cache, v_cache, block_table, context_lens):
    B, Hq, Sq, D = q.shape
    bs = k_cache.shape[1]
    Hkv = k_cache.shape[2]
    nbps = block_table.shape[1]
    Skv = nbps * bs
    bt = block_table.reshape(-1)
    k = (lambda x, *d: x.permute(*d))(k_cache[bt].reshape(B, Skv, Hkv, D), 0, 2, 1, 3)
    v = (lambda x, *d: x.permute(*d))(v_cache[bt].reshape(B, Skv, Hkv, D), 0, 2, 1, 3)
    g = Hq // Hkv
    qg = q.reshape(B, Hkv, g, Sq, D)
    scores = torch.einsum("bhgqd,bhkd->bhgqk", qg, k) * (D ** -0.5)
    pos = torch.arange(Skv)
    msk = pos[None, :] < context_lens[:, None]
    scores = torch.where(msk[:, None, None, None, :], scores, -1e9)
    p = _softmax(scores, axis=-1)
    out = torch.einsum("bhgqk,bhkd->bhgqd", p, v)
    return out.reshape(B, Hq, Sq, D)
```

```asm
; @launch grid=(256,1,1) block=(320,1,1) lds=576
.amdgcn_target "amdgcn-amd-amdhsa--gfx950"
.text
.globl standalone__paged_block_table_kv_pagedattention__sampling_kernel
.p2align 8
.type standalone__paged_block_table_kv_pagedattention__sampling_kernel,@function
standalone__paged_block_table_kv_pagedattention__sampling_kernel:

    s_load_dwordx16 s[4:19], s[0:1], 0
    v_readfirstlane_b32 s56, v0
    s_cmpk_ge_u32 s2, 0x100
    s_cbranch_scc1 DONE0
    s_cmpk_eq_u32 s56, 0x100
    s_cbranch_scc1 PAD0

    s_and_b32 s70, s2, 3
    s_mov_b32 s44, 0x81631a8
    s_mov_b32 s45, 0x62929ea
    s_cmp_eq_u32 s70, 1
    s_cmov_b32 s44, 0x2ce913b6
    s_cmov_b32 s45, 0x23380ac8
    s_cmp_eq_u32 s70, 2
    s_cmov_b32 s44, 0xd2a2086
    s_cmov_b32 s45, 0x3e082aa7
    s_cmp_eq_u32 s70, 3
    s_cmov_b32 s44, 0x32ba0fd7
    s_cmov_b32 s45, 0x1b7a1fc9
    s_and_b32 s35, s2, 12
    s_lshl_b32 s35, s35, 2

    s_and_b32 s74, s2, 48
    s_or_b32 s74, s74, s56
    s_lshr_b32 s74, s74, 4
    s_lshr_b64 s[78:79], s[44:45], s35
    s_and_b32 s58, s78, 15
    s_sub_u32 s71, 16, s58
    s_sub_u32 s32, s74, s58

    s_cselect_b32 s70, 4, 9
    s_cselect_b32 s32, s74, s32
    s_cselect_b32 s58, s58, s71
    s_lshr_b32 s57, s78, s70
    s_and_b32 s57, s57, 31
    v_and_b32 v28, 15, v0

    v_sub_u32 v21, 15, v28

    s_lshl_b32 s47, s57, 7
    s_add_u32 s70, s47, s32
    v_mul_i32_i24 v26, s58, v21

    v_add_u32 v26, s70, v26

    v_min_u32 v22, 0xfff, v26
    v_lshlrev_b32 v22, 2, v22

    v_and_b32 v1, 63, v0
    v_lshrrev_b32 v29, 4, v1
    v_lshrrev_b32 v23, 3, v28
    v_and_b32 v27, 7, v1
    v_lshlrev_b32 v14, 8, v27
    v_and_b32 v20, 31, v0
    v_lshlrev_b32 v6, 2, v20
    s_add_u32 s59, s57, 1
    s_mulk_i32 s59, 433
    s_waitcnt lgkmcnt(0)
    global_load_dword v13, v22, s[10:11]
ENTRY_END:
    v_lshl_add_u32 v14, v29, 5, v14
    s_branch SKIP0
PAD0:
    s_branch PAD1
SKIP0:
    v_lshl_add_u32 v14, v23, 4, v14
    s_and_b32 s59, s59, 0x3ff
    s_sub_u32 s59, 0x800, s59
    s_mov_b32 s30, 0x40000
    s_mov_b32 s31, 0x00020000
    s_xor_b32 s56, s56, s2
    s_lshr_b32 s56, s56, 6
    s_mov_b32 s22, 0x4010000

    s_movk_i32 s70, 433
    v_mad_u32_u24 v30, v20, s70, s70
    v_and_b32 v30, 0x3ff, v30
    v_sub_u32 v30, 0x800, v30

    s_lshr_b32 s46, s2, 4
    s_xor_b32 s70, s35, 16
    s_lshr_b64 s[78:79], s[44:45], s70
    s_and_b32 s68, s78, 15
    s_sub_u32 s71, 16, s68
    s_cmp_lt_u32 s46, 8
    s_cselect_b32 s70, 4, 9
    s_cselect_b32 s68, s68, s71
    s_lshr_b32 s75, s78, s70
    s_and_b32 s75, s75, 31
    s_lshl_b32 s34, s75, 5
    s_and_b32 s70, s46, 7
    s_lshl3_add_u32 s75, s75, s70
    s_and_b32 s70, s46, 3
    s_lshl3_add_u32 s34, s70, s34
    s_and_b32 s70, s46, 4
    s_or_b32 s34, s34, s70

    v_mov_b32 v11, 0x40000000
    v_mov_b32 v10, 0xff000000

COMMON:
    s_mov_b32 s28, s4
    s_mov_b32 s29, s5

    s_lshl_b32 s66, s57, 13
    s_lshl_b32 s70, s56, 11
    s_add_u32 s66, s66, s70
    buffer_load_dwordx4 v[32:35], v14, s[28:31], s66 offen
    buffer_load_dwordx4 v[36:39], v14, s[28:31], s66 offen offset:128
    global_load_dword v31, v6, s[12:13]

    s_lshl_b32 s33, s57, 5
    s_lshl3_add_u32 s33, s56, s33
    s_load_dwordx2 s[82:83], s[18:19], s33
    s_load_dword s3, s[18:19], s34
    s_add_u32 s70, s59, 15
    s_lshr_b32 s70, s70, 4
    s_add_u32 s47, s47, s70
    v_cmp_gt_u32 vcc, s47, v26
    s_lshl_b32 s74, s56, 8
    v_mov_b32 v15, s74
    s_mov_b32 s23, 0x00020000
    v_cndmask_b32 v15, v11, v15, vcc
    s_bcnt1_i32_b64 s60, vcc
    s_lshr_b32 s60, s60, 2
    s_lshl_b32 s65, s58, 4
    s_add_u32 s74, s60, 5
    s_min_u32 s74, s74, 15
    s_mul_i32 s64, s65, s74
    s_lshl4_add_u32 s64, s32, s64
    s_sub_u32 s64, s59, s64
    s_sub_u32 s74, 16, s60

    s_mov_b32 s20, s6
    s_mov_b32 s21, s7
    s_mov_b32 s24, s8
    s_mov_b32 s25, s9
    s_mov_b32 s26, 0x4010000
    s_mov_b32 s27, 0x00020000

    v_and_b32 v25, 1, v1
    v_lshlrev_b32 v2, 4, v25
    v_lshl_add_u32 v2, v29, 5, v2
    v_lshrrev_b32 v24, 1, v28
    v_lshl_add_u32 v2, v24, 11, v2
    v_lshl_add_u32 v4, v29, 2, v23
    v_add_u32 v5, 2, v4

    v_lshlrev_b32 v3, 4, v25
    v_and_b32 v24, 1, v24
    v_lshl_add_u32 v3, v24, 7, v3
    v_lshrrev_b32 v24, 2, v28
    v_lshl_add_u32 v3, v24, 5, v3
    v_lshl_add_u32 v3, v29, 12, v3
    v_mov_b32 v16, v10

    v_mov_b32 v56, v10
    v_mov_b32 v57, v10
    v_mov_b32 v58, v10
    v_mov_b32 v59, v10
    v_mov_b32 v60, v10
    v_mov_b32 v61, v10
    v_mov_b32 v62, v10
    v_mov_b32 v63, v10
    v_mov_b32 v64, v10
    v_mov_b32 v65, v10
    v_mov_b32 v66, v10
    v_mov_b32 v67, v10
    v_mov_b32 v68, v10
    v_mov_b32 v69, v10
    v_mov_b32 v70, v10
    v_mov_b32 v71, v10
    v_mov_b32 v72, v10
    v_mov_b32 v73, v10
    s_waitcnt vmcnt(3)

    v_lshl_add_u32 v13, v13, 14, v15
    s_nop 0
    v_readlane_b32 s48, v13, s74
    v_readlane_b32 s49, v13, s74
    s_nop 1

    s_cmp_eq_u32 s60, 12
    s_cbranch_scc1 E4
    s_cmp_eq_u32 s60, 13
    s_cbranch_scc1 E3
    s_cmp_eq_u32 s60, 11
    s_cbranch_scc1 E5
    s_cmp_eq_u32 s60, 10
    s_cbranch_scc1 E6
    s_cmp_eq_u32 s60, 14
    s_cbranch_scc1 E2
    s_cmp_eq_u32 s60, 15
    s_cbranch_scc1 E1
    s_cmp_eq_u32 s60, 9
    s_cbranch_scc1 E7
    s_cmp_eq_u32 s60, 8
    s_cbranch_scc1 E8
    s_cmp_eq_u32 s60, 7
    s_cbranch_scc1 E9
    s_cmp_eq_u32 s60, 6
    s_cbranch_scc1 E10
    s_cmp_eq_u32 s60, 5
    s_cbranch_scc1 E11
    s_cmp_eq_u32 s60, 4
    s_cbranch_scc1 E12
    s_cmp_eq_u32 s60, 3
    s_cbranch_scc1 E13
    s_cmp_eq_u32 s60, 2
    s_cbranch_scc1 E14
    s_cmp_eq_u32 s60, 1
    s_cbranch_scc1 E15
    s_cmp_eq_u32 s60, 0
    s_cbranch_scc1 KZERO
E0:
    v_readlane_b32 s49, v13, 1
    buffer_load_dwordx4 v[128:131], v2, s[20:23], s48 offen offset:0 nt
    buffer_load_dwordx4 v[132:135], v2, s[20:23], s48 offen offset:1024 nt
    buffer_load_dwordx4 v[136:139], v2, s[20:23], s48 offen offset:128 nt
    buffer_load_dwordx4 v[140:143], v2, s[20:23], s48 offen offset:1152 nt
E1:
    v_readlane_b32 s48, v13, 2
    buffer_load_dwordx4 v[144:147], v2, s[20:23], s49 offen offset:0 nt
    buffer_load_dwordx4 v[148:151], v2, s[20:23], s49 offen offset:1024 nt
    buffer_load_dwordx4 v[152:155], v2, s[20:23], s49 offen offset:128 nt
    buffer_load_dwordx4 v[156:159], v2, s[20:23], s49 offen offset:1152 nt
E2:
    v_readlane_b32 s49, v13, 3
    buffer_load_dwordx4 v[160:163], v2, s[20:23], s48 offen offset:0 nt
    buffer_load_dwordx4 v[164:167], v2, s[20:23], s48 offen offset:1024 nt
    buffer_load_dwordx4 v[168:171], v2, s[20:23], s48 offen offset:128 nt
    buffer_load_dwordx4 v[172:175], v2, s[20:23], s48 offen offset:1152 nt
E3:
    v_readlane_b32 s48, v13, 4
    buffer_load_dwordx4 v[176:179], v2, s[20:23], s49 offen offset:0 nt
    buffer_load_dwordx4 v[180:183], v2, s[20:23], s49 offen offset:1024 nt
    buffer_load_dwordx4 v[184:187], v2, s[20:23], s49 offen offset:128 nt
    buffer_load_dwordx4 v[188:191], v2, s[20:23], s49 offen offset:1152 nt
E4:
    v_readlane_b32 s49, v13, 5
    buffer_load_dwordx4 v[192:195], v2, s[20:23], s48 offen offset:0 nt
    buffer_load_dwordx4 v[196:199], v2, s[20:23], s48 offen offset:1024 nt
    buffer_load_dwordx4 v[200:203], v2, s[20:23], s48 offen offset:128 nt
    buffer_load_dwordx4 v[204:207], v2, s[20:23], s48 offen offset:1152 nt
E5:
    v_readlane_b32 s48, v13, 6
    buffer_load_dwordx4 v[208:211], v2, s[20:23], s49 offen offset:0 nt
    buffer_load_dwordx4 v[212:215], v2, s[20:23], s49 offen offset:1024 nt
    buffer_load_dwordx4 v[216:219], v2, s[20:23], s49 offen offset:128 nt
    buffer_load_dwordx4 v[220:223], v2, s[20:23], s49 offen offset:1152 nt
E6:
    s_waitcnt vmcnt(20)

    v_mfma_f32_16x16x32_bf16 v[96:99], v[128:131], v[32:35], 0
    v_mfma_f32_16x16x32_bf16 v[100:103], v[132:135], v[32:35], 0
    v_mfma_f32_16x16x32_bf16 v[96:99], v[136:139], v[36:39], v[96:99]
    v_mfma_f32_16x16x32_bf16 v[100:103], v[140:143], v[36:39], v[100:103]

    v_readlane_b32 s49, v13, 7
    buffer_load_dwordx4 v[128:131], v2, s[20:23], s48 offen offset:0 nt
    buffer_load_dwordx4 v[132:135], v2, s[20:23], s48 offen offset:1024 nt
    buffer_load_dwordx4 v[136:139], v2, s[20:23], s48 offen offset:128 nt
    buffer_load_dwordx4 v[140:143], v2, s[20:23], s48 offen offset:1152 nt

    v_cmp_gt_i32 s[78:79], s64, v4
    v_cmp_gt_i32 s[80:81], s64, v5
    s_add_u32 s64, s64, s65
    v_add_f32_dpp v56, v97, v96 row_ror:8 row_mask:0xf bank_mask:0x3
    v_add_f32_dpp v57, v99, v98 row_ror:8 row_mask:0xf bank_mask:0x3
    s_nop 0
    v_add_f32_dpp v56, v100, v101 row_ror:8 row_mask:0xf bank_mask:0xc
    s_branch SKIP1
PAD1:
    s_branch PAD2
SKIP1:
    v_add_f32_dpp v57, v102, v103 row_ror:8 row_mask:0xf bank_mask:0xc
    v_cndmask_b32 v56, v10, v56, s[78:79]
    v_cndmask_b32 v57, v10, v57, s[80:81]
    v_max3_f32 v16, v16, v56, v57

E7:
    s_waitcnt vmcnt(20)

    v_mfma_f32_16x16x32_bf16 v[96:99], v[144:147], v[32:35], 0
    v_mfma_f32_16x16x32_bf16 v[100:103], v[148:151], v[32:35], 0
    v_mfma_f32_16x16x32_bf16 v[96:99], v[152:155], v[36:39], v[96:99]
    v_mfma_f32_16x16x32_bf16 v[100:103], v[156:159], v[36:39], v[100:103]

    v_readlane_b32 s48, v13, 8
    buffer_load_dwordx4 v[144:147], v2, s[20:23], s49 offen offset:0 nt
    buffer_load_dwordx4 v[148:151], v2, s[20:23], s49 offen offset:1024 nt
    buffer_load_dwordx4 v[152:155], v2, s[20:23], s49 offen offset:128 nt
    buffer_load_dwordx4 v[156:159], v2, s[20:23], s49 offen offset:1152 nt

    v_cmp_gt_i32 s[78:79], s64, v4
    v_cmp_gt_i32 s[80:81], s64, v5
    s_add_u32 s64, s64, s65
    v_add_f32_dpp v58, v97, v96 row_ror:8 row_mask:0xf bank_mask:0x3
    v_add_f32_dpp v59, v99, v98 row_ror:8 row_mask:0xf bank_mask:0x3
    s_nop 0
    v_add_f32_dpp v58, v100, v101 row_ror:8 row_mask:0xf bank_mask:0xc
    v_add_f32_dpp v59, v102, v103 row_ror:8 row_mask:0xf bank_mask:0xc
    v_cndmask_b32 v58, v10, v58, s[78:79]
    v_cndmask_b32 v59, v10, v59, s[80:81]
    v_max3_f32 v16, v16, v58, v59

E8:
    s_waitcnt vmcnt(20)

    v_mfma_f32_16x16x32_bf16 v[96:99], v[160:163], v[32:35], 0
    v_mfma_f32_16x16x32_bf16 v[100:103], v[164:167], v[32:35], 0
    v_mfma_f32_16x16x32_bf16 v[96:99], v[168:171], v[36:39], v[96:99]
    v_mfma_f32_16x16x32_bf16 v[100:103], v[172:175], v[36:39], v[100:103]

    v_readlane_b32 s49, v13, 9
    buffer_load_dwordx4 v[160:163], v2, s[20:23], s48 offen offset:0 nt
    buffer_load_dwordx4 v[164:167], v2, s[20:23], s48 offen offset:1024 nt
    buffer_load_dwordx4 v[168:171], v2, s[20:23], s48 offen offset:128 nt
    buffer_load_dwordx4 v[172:175], v2, s[20:23], s48 offen offset:1152 nt

    v_cmp_gt_i32 s[78:79], s64, v4
    v_cmp_gt_i32 s[80:81], s64, v5
    s_add_u32 s64, s64, s65
    v_add_f32_dpp v60, v97, v96 row_ror:8 row_mask:0xf bank_mask:0x3
    v_add_f32_dpp v61, v99, v98 row_ror:8 row_mask:0xf bank_mask:0x3
    s_nop 0
    v_add_f32_dpp v60, v100, v101 row_ror:8 row_mask:0xf bank_mask:0xc
    v_add_f32_dpp v61, v102, v103 row_ror:8 row_mask:0xf bank_mask:0xc
    v_cndmask_b32 v60, v10, v60, s[78:79]
    v_cndmask_b32 v61, v10, v61, s[80:81]
    v_max3_f32 v16, v16, v60, v61

E9:
    s_waitcnt vmcnt(20)

    v_mfma_f32_16x16x32_bf16 v[96:99], v[176:179], v[32:35], 0
    v_mfma_f32_16x16x32_bf16 v[100:103], v[180:183], v[32:35], 0
    v_mfma_f32_16x16x32_bf16 v[96:99], v[184:187], v[36:39], v[96:99]
    v_mfma_f32_16x16x32_bf16 v[100:103], v[188:191], v[36:39], v[100:103]

    v_readlane_b32 s48, v13, 10
    buffer_load_dwordx4 v[176:179], v2, s[20:23], s49 offen offset:0 nt
    buffer_load_dwordx4 v[180:183], v2, s[20:23], s49 offen offset:1024 nt
    buffer_load_dwordx4 v[184:187], v2, s[20:23], s49 offen offset:128 nt
    buffer_load_dwordx4 v[188:191], v2, s[20:23], s49 offen offset:1152 nt

    v_cmp_gt_i32 s[78:79], s64, v4
    v_cmp_gt_i32 s[80:81], s64, v5
    s_add_u32 s64, s64, s65
    v_add_f32_dpp v62, v97, v96 row_ror:8 row_mask:0xf bank_mask:0x3
    v_add_f32_dpp v63, v99, v98 row_ror:8 row_mask:0xf bank_mask:0x3
    s_nop 0
    v_add_f32_dpp v62, v100, v101 row_ror:8 row_mask:0xf bank_mask:0xc
    v_add_f32_dpp v63, v102, v103 row_ror:8 row_mask:0xf bank_mask:0xc
    v_cndmask_b32 v62, v10, v62, s[78:79]
    v_cndmask_b32 v63, v10, v63, s[80:81]
    v_max3_f32 v16, v16, v62, v63

E10:
    s_waitcnt vmcnt(20)

    v_mfma_f32_16x16x32_bf16 v[96:99], v[192:195], v[32:35], 0
    v_mfma_f32_16x16x32_bf16 v[100:103], v[196:199], v[32:35], 0
    v_mfma_f32_16x16x32_bf16 v[96:99], v[200:203], v[36:39], v[96:99]
    v_mfma_f32_16x16x32_bf16 v[100:103], v[204:207], v[36:39], v[100:103]

    v_readlane_b32 s49, v13, 11
    buffer_load_dwordx4 v[192:195], v2, s[20:23], s48 offen offset:0 nt
    buffer_load_dwordx4 v[196:199], v2, s[20:23], s48 offen offset:1024 nt
    buffer_load_dwordx4 v[200:203], v2, s[20:23], s48 offen offset:128 nt
    buffer_load_dwordx4 v[204:207], v2, s[20:23], s48 offen offset:1152 nt

    v_cmp_gt_i32 s[78:79], s64, v4
    v_cmp_gt_i32 s[80:81], s64, v5
    s_add_u32 s64, s64, s65
    v_add_f32_dpp v64, v97, v96 row_ror:8 row_mask:0xf bank_mask:0x3
    v_add_f32_dpp v65, v99, v98 row_ror:8 row_mask:0xf bank_mask:0x3
    s_nop 0
    v_add_f32_dpp v64, v100, v101 row_ror:8 row_mask:0xf bank_mask:0xc
    v_add_f32_dpp v65, v102, v103 row_ror:8 row_mask:0xf bank_mask:0xc
    v_cndmask_b32 v64, v10, v64, s[78:79]
    v_cndmask_b32 v65, v10, v65, s[80:81]
    v_max3_f32 v16, v16, v64, v65

E11:
    s_waitcnt vmcnt(20)

    v_mfma_f32_16x16x32_bf16 v[96:99], v[208:211], v[32:35], 0
    v_mfma_f32_16x16x32_bf16 v[100:103], v[212:215], v[32:35], 0
    v_mfma_f32_16x16x32_bf16 v[96:99], v[216:219], v[36:39], v[96:99]
    v_mfma_f32_16x16x32_bf16 v[100:103], v[220:223], v[36:39], v[100:103]

    v_readlane_b32 s48, v13, 12
    buffer_load_dwordx4 v[208:211], v2, s[20:23], s49 offen offset:0 nt
    buffer_load_dwordx4 v[212:215], v2, s[20:23], s49 offen offset:1024 nt
    buffer_load_dwordx4 v[216:219], v2, s[20:23], s49 offen offset:128 nt
    buffer_load_dwordx4 v[220:223], v2, s[20:23], s49 offen offset:1152 nt

    v_cmp_gt_i32 s[78:79], s64, v4
    v_cmp_gt_i32 s[80:81], s64, v5
    s_add_u32 s64, s64, s65
    v_add_f32_dpp v66, v97, v96 row_ror:8 row_mask:0xf bank_mask:0x3
    v_add_f32_dpp v67, v99, v98 row_ror:8 row_mask:0xf bank_mask:0x3
    s_nop 0
    v_add_f32_dpp v66, v100, v101 row_ror:8 row_mask:0xf bank_mask:0xc
    v_add_f32_dpp v67, v102, v103 row_ror:8 row_mask:0xf bank_mask:0xc
    v_cndmask_b32 v66, v10, v66, s[78:79]
    v_cndmask_b32 v67, v10, v67, s[80:81]
    v_max3_f32 v16, v16, v66, v67

E12:
    s_waitcnt vmcnt(20)

    v_mfma_f32_16x16x32_bf16 v[96:99], v[128:131], v[32:35], 0
    v_mfma_f32_16x16x32_bf16 v[100:103], v[132:135], v[32:35], 0
    v_mfma_f32_16x16x32_bf16 v[96:99], v[136:139], v[36:39], v[96:99]
    v_mfma_f32_16x16x32_bf16 v[100:103], v[140:143], v[36:39], v[100:103]

    v_readlane_b32 s49, v13, 13
    buffer_load_dwordx4 v[128:131], v2, s[20:23], s48 offen offset:0 nt
    buffer_load_dwordx4 v[132:135], v2, s[20:23], s48 offen offset:1024 nt
    buffer_load_dwordx4 v[136:139], v2, s[20:23], s48 offen offset:128 nt
    buffer_load_dwordx4 v[140:143], v2, s[20:23], s48 offen offset:1152 nt

    v_cmp_gt_i32 s[78:79], s64, v4
    v_cmp_gt_i32 s[80:81], s64, v5
    s_add_u32 s64, s64, s65
    v_add_f32_dpp v68, v97, v96 row_ror:8 row_mask:0xf bank_mask:0x3
    v_add_f32_dpp v69, v99, v98 row_ror:8 row_mask:0xf bank_mask:0x3
    s_nop 0
    v_add_f32_dpp v68, v100, v101 row_ror:8 row_mask:0xf bank_mask:0xc
    v_add_f32_dpp v69, v102, v103 row_ror:8 row_mask:0xf bank_mask:0xc
    v_cndmask_b32 v68, v10, v68, s[78:79]
    v_cndmask_b32 v69, v10, v69, s[80:81]
    v_max3_f32 v16, v16, v68, v69

E13:
    s_waitcnt vmcnt(20)

    v_mfma_f32_16x16x32_bf16 v[96:99], v[144:147], v[32:35], 0
    v_mfma_f32_16x16x32_bf16 v[100:103], v[148:151], v[32:35], 0
    v_mfma_f32_16x16x32_bf16 v[96:99], v[152:155], v[36:39], v[96:99]
    v_mfma_f32_16x16x32_bf16 v[100:103], v[156:159], v[36:39], v[100:103]

    v_readlane_b32 s48, v13, 14
    s_branch SKIP2
PAD2:
    s_branch PAD3
SKIP2:
    buffer_load_dwordx4 v[144:147], v2, s[20:23], s49 offen offset:0 nt
    buffer_load_dwordx4 v[148:151], v2, s[20:23], s49 offen offset:1024 nt
    buffer_load_dwordx4 v[152:155], v2, s[20:23], s49 offen offset:128 nt
    buffer_load_dwordx4 v[156:159], v2, s[20:23], s49 offen offset:1152 nt

    v_cmp_gt_i32 s[78:79], s64, v4
    v_cmp_gt_i32 s[80:81], s64, v5
    s_add_u32 s64, s64, s65
    v_add_f32_dpp v70, v97, v96 row_ror:8 row_mask:0xf bank_mask:0x3
    v_add_f32_dpp v71, v99, v98 row_ror:8 row_mask:0xf bank_mask:0x3
    s_nop 0
    v_add_f32_dpp v70, v100, v101 row_ror:8 row_mask:0xf bank_mask:0xc
    v_add_f32_dpp v71, v102, v103 row_ror:8 row_mask:0xf bank_mask:0xc
    v_cndmask_b32 v70, v10, v70, s[78:79]
    v_cndmask_b32 v71, v10, v71, s[80:81]
    v_max3_f32 v16, v16, v70, v71

E14:
    s_waitcnt vmcnt(20)

    v_mfma_f32_16x16x32_bf16 v[96:99], v[160:163], v[32:35], 0
    v_mfma_f32_16x16x32_bf16 v[100:103], v[164:167], v[32:35], 0
    v_mfma_f32_16x16x32_bf16 v[96:99], v[168:171], v[36:39], v[96:99]
    v_mfma_f32_16x16x32_bf16 v[100:103], v[172:175], v[36:39], v[100:103]

    v_readlane_b32 s49, v13, 15
    buffer_load_dwordx4 v[160:163], v2, s[20:23], s48 offen offset:0 nt
    buffer_load_dwordx4 v[164:167], v2, s[20:23], s48 offen offset:1024 nt
    buffer_load_dwordx4 v[168:171], v2, s[20:23], s48 offen offset:128 nt
    buffer_load_dwordx4 v[172:175], v2, s[20:23], s48 offen offset:1152 nt

    v_cmp_gt_i32 s[78:79], s64, v4
    v_cmp_gt_i32 s[80:81], s64, v5
    s_add_u32 s64, s64, s65
    v_add_f32_dpp v72, v97, v96 row_ror:8 row_mask:0xf bank_mask:0x3
    v_add_f32_dpp v73, v99, v98 row_ror:8 row_mask:0xf bank_mask:0x3
    s_nop 0
    v_add_f32_dpp v72, v100, v101 row_ror:8 row_mask:0xf bank_mask:0xc
    v_add_f32_dpp v73, v102, v103 row_ror:8 row_mask:0xf bank_mask:0xc
    v_cndmask_b32 v72, v10, v72, s[78:79]
    v_cndmask_b32 v73, v10, v73, s[80:81]
    v_max3_f32 v16, v16, v72, v73

E15:
    s_waitcnt vmcnt(20)

    v_mfma_f32_16x16x32_bf16 v[96:99], v[176:179], v[32:35], 0
    v_mfma_f32_16x16x32_bf16 v[100:103], v[180:183], v[32:35], 0
    v_mfma_f32_16x16x32_bf16 v[96:99], v[184:187], v[36:39], v[96:99]
    v_mfma_f32_16x16x32_bf16 v[100:103], v[188:191], v[36:39], v[100:103]

    v_readlane_b32 s48, v13, 15
    buffer_load_dwordx4 v[176:179], v2, s[20:23], s49 offen offset:0 nt
    buffer_load_dwordx4 v[180:183], v2, s[20:23], s49 offen offset:1024 nt
    buffer_load_dwordx4 v[184:187], v2, s[20:23], s49 offen offset:128 nt
    buffer_load_dwordx4 v[188:191], v2, s[20:23], s49 offen offset:1152 nt

    v_cmp_gt_i32 s[78:79], s64, v4
    v_cmp_gt_i32 s[80:81], s64, v5
    s_add_u32 s64, s64, s65
    v_add_f32_dpp v74, v97, v96 row_ror:8 row_mask:0xf bank_mask:0x3
    v_add_f32_dpp v75, v99, v98 row_ror:8 row_mask:0xf bank_mask:0x3
    s_nop 0
    v_add_f32_dpp v74, v100, v101 row_ror:8 row_mask:0xf bank_mask:0xc
    v_add_f32_dpp v75, v102, v103 row_ror:8 row_mask:0xf bank_mask:0xc
    v_cndmask_b32 v74, v10, v74, s[78:79]
    v_cndmask_b32 v75, v10, v75, s[80:81]
    v_max3_f32 v16, v16, v74, v75

    s_waitcnt vmcnt(20)

    v_mfma_f32_16x16x32_bf16 v[96:99], v[192:195], v[32:35], 0
    v_mfma_f32_16x16x32_bf16 v[100:103], v[196:199], v[32:35], 0
    v_mfma_f32_16x16x32_bf16 v[96:99], v[200:203], v[36:39], v[96:99]
    v_mfma_f32_16x16x32_bf16 v[100:103], v[204:207], v[36:39], v[100:103]

    v_readlane_b32 s49, v13, 14
    buffer_load_dwordx4 v[192:195], v3, s[24:27], s48 offen offset:0 nt
    buffer_load_dwordx4 v[196:199], v3, s[24:27], s48 offen offset:1024 nt
    buffer_load_dwordx4 v[200:203], v3, s[24:27], s48 offen offset:2048 nt
    buffer_load_dwordx4 v[204:207], v3, s[24:27], s48 offen offset:3072 nt

    v_cmp_gt_i32 s[78:79], s64, v4
    v_cmp_gt_i32 s[80:81], s64, v5
    s_add_u32 s64, s64, s65
    v_add_f32_dpp v76, v97, v96 row_ror:8 row_mask:0xf bank_mask:0x3
    v_add_f32_dpp v77, v99, v98 row_ror:8 row_mask:0xf bank_mask:0x3
    s_nop 0
    v_add_f32_dpp v76, v100, v101 row_ror:8 row_mask:0xf bank_mask:0xc
    v_add_f32_dpp v77, v102, v103 row_ror:8 row_mask:0xf bank_mask:0xc
    v_cndmask_b32 v76, v10, v76, s[78:79]
    v_cndmask_b32 v77, v10, v77, s[80:81]
    v_max3_f32 v16, v16, v76, v77

    s_waitcnt vmcnt(20)

    v_mfma_f32_16x16x32_bf16 v[96:99], v[208:211], v[32:35], 0
    v_mfma_f32_16x16x32_bf16 v[100:103], v[212:215], v[32:35], 0
    v_mfma_f32_16x16x32_bf16 v[96:99], v[216:219], v[36:39], v[96:99]
    v_mfma_f32_16x16x32_bf16 v[100:103], v[220:223], v[36:39], v[100:103]

    v_readlane_b32 s48, v13, 13
    buffer_load_dwordx4 v[208:211], v3, s[24:27], s49 offen offset:0 nt
    buffer_load_dwordx4 v[212:215], v3, s[24:27], s49 offen offset:1024 nt
    buffer_load_dwordx4 v[216:219], v3, s[24:27], s49 offen offset:2048 nt
    buffer_load_dwordx4 v[220:223], v3, s[24:27], s49 offen offset:3072 nt

    v_cmp_gt_i32 s[78:79], s64, v4
    v_cmp_gt_i32 s[80:81], s64, v5
    s_add_u32 s64, s64, s65
    v_add_f32_dpp v78, v97, v96 row_ror:8 row_mask:0xf bank_mask:0x3
    v_add_f32_dpp v79, v99, v98 row_ror:8 row_mask:0xf bank_mask:0x3
    s_nop 0
    v_add_f32_dpp v78, v100, v101 row_ror:8 row_mask:0xf bank_mask:0xc
    v_add_f32_dpp v79, v102, v103 row_ror:8 row_mask:0xf bank_mask:0xc
    v_cndmask_b32 v78, v10, v78, s[78:79]
    v_cndmask_b32 v79, v10, v79, s[80:81]
    v_max3_f32 v16, v16, v78, v79

    s_waitcnt vmcnt(20)

    v_mfma_f32_16x16x32_bf16 v[96:99], v[128:131], v[32:35], 0
    v_mfma_f32_16x16x32_bf16 v[100:103], v[132:135], v[32:35], 0
    v_mfma_f32_16x16x32_bf16 v[96:99], v[136:139], v[36:39], v[96:99]
    v_mfma_f32_16x16x32_bf16 v[100:103], v[140:143], v[36:39], v[100:103]

    v_readlane_b32 s49, v13, 12
    buffer_load_dwordx4 v[128:131], v3, s[24:27], s48 offen offset:0 nt
    buffer_load_dwordx4 v[132:135], v3, s[24:27], s48 offen offset:1024 nt
    buffer_load_dwordx4 v[136:139], v3, s[24:27], s48 offen offset:2048 nt
    buffer_load_dwordx4 v[140:143], v3, s[24:27], s48 offen offset:3072 nt

    v_cmp_gt_i32 s[78:79], s64, v4
    v_cmp_gt_i32 s[80:81], s64, v5
    s_add_u32 s64, s64, s65
    v_add_f32_dpp v80, v97, v96 row_ror:8 row_mask:0xf bank_mask:0x3
    v_add_f32_dpp v81, v99, v98 row_ror:8 row_mask:0xf bank_mask:0x3
    s_nop 0
    v_add_f32_dpp v80, v100, v101 row_ror:8 row_mask:0xf bank_mask:0xc
    v_add_f32_dpp v81, v102, v103 row_ror:8 row_mask:0xf bank_mask:0xc
    v_cndmask_b32 v80, v10, v80, s[78:79]
    v_cndmask_b32 v81, v10, v81, s[80:81]
    v_max3_f32 v16, v16, v80, v81

    s_waitcnt vmcnt(20)

    v_mfma_f32_16x16x32_bf16 v[96:99], v[144:147], v[32:35], 0
    v_mfma_f32_16x16x32_bf16 v[100:103], v[148:151], v[32:35], 0
    v_mfma_f32_16x16x32_bf16 v[96:99], v[152:155], v[36:39], v[96:99]
    v_mfma_f32_16x16x32_bf16 v[100:103], v[156:159], v[36:39], v[100:103]

    v_readlane_b32 s48, v13, 11
    buffer_load_dwordx4 v[144:147], v3, s[24:27], s49 offen offset:0 nt
    buffer_load_dwordx4 v[148:151], v3, s[24:27], s49 offen offset:1024 nt
    buffer_load_dwordx4 v[152:155], v3, s[24:27], s49 offen offset:2048 nt
    buffer_load_dwordx4 v[156:159], v3, s[24:27], s49 offen offset:3072 nt

    v_cmp_gt_i32 s[78:79], s64, v4
    v_cmp_gt_i32 s[80:81], s64, v5
    s_add_u32 s64, s64, s65
    v_add_f32_dpp v82, v97, v96 row_ror:8 row_mask:0xf bank_mask:0x3
    v_add_f32_dpp v83, v99, v98 row_ror:8 row_mask:0xf bank_mask:0x3
    s_nop 0
    v_add_f32_dpp v82, v100, v101 row_ror:8 row_mask:0xf bank_mask:0xc
    s_branch SKIP3
PAD3:
    s_branch PAD4
SKIP3:
    v_add_f32_dpp v83, v102, v103 row_ror:8 row_mask:0xf bank_mask:0xc
    v_cndmask_b32 v82, v10, v82, s[78:79]
    v_cndmask_b32 v83, v10, v83, s[80:81]
    v_max3_f32 v16, v16, v82, v83

    s_waitcnt vmcnt(20)

    v_mfma_f32_16x16x32_bf16 v[96:99], v[160:163], v[32:35], 0
    v_mfma_f32_16x16x32_bf16 v[100:103], v[164:167], v[32:35], 0
    v_mfma_f32_16x16x32_bf16 v[96:99], v[168:171], v[36:39], v[96:99]
    v_mfma_f32_16x16x32_bf16 v[100:103], v[172:175], v[36:39], v[100:103]

    v_readlane_b32 s49, v13, 10
    buffer_load_dwordx4 v[160:163], v3, s[24:27], s48 offen offset:0 nt
    buffer_load_dwordx4 v[164:167], v3, s[24:27], s48 offen offset:1024 nt
    buffer_load_dwordx4 v[168:171], v3, s[24:27], s48 offen offset:2048 nt
    buffer_load_dwordx4 v[172:175], v3, s[24:27], s48 offen offset:3072 nt

    v_cmp_gt_i32 s[78:79], s64, v4
    v_cmp_gt_i32 s[80:81], s64, v5
    s_add_u32 s64, s64, s65
    v_add_f32_dpp v84, v97, v96 row_ror:8 row_mask:0xf bank_mask:0x3
    v_add_f32_dpp v85, v99, v98 row_ror:8 row_mask:0xf bank_mask:0x3
    s_nop 0
    v_add_f32_dpp v84, v100, v101 row_ror:8 row_mask:0xf bank_mask:0xc
    v_add_f32_dpp v85, v102, v103 row_ror:8 row_mask:0xf bank_mask:0xc
    v_cndmask_b32 v84, v10, v84, s[78:79]
    v_cndmask_b32 v85, v10, v85, s[80:81]
    v_max3_f32 v16, v16, v84, v85

    s_waitcnt vmcnt(20)

    v_mfma_f32_16x16x32_bf16 v[96:99], v[176:179], v[32:35], 0
    v_mfma_f32_16x16x32_bf16 v[100:103], v[180:183], v[32:35], 0
    v_mfma_f32_16x16x32_bf16 v[96:99], v[184:187], v[36:39], v[96:99]
    v_mfma_f32_16x16x32_bf16 v[100:103], v[188:191], v[36:39], v[100:103]

    v_readlane_b32 s48, v13, 9
    buffer_load_dwordx4 v[176:179], v3, s[24:27], s49 offen offset:0 nt
    buffer_load_dwordx4 v[180:183], v3, s[24:27], s49 offen offset:1024 nt
    buffer_load_dwordx4 v[184:187], v3, s[24:27], s49 offen offset:2048 nt
    buffer_load_dwordx4 v[188:191], v3, s[24:27], s49 offen offset:3072 nt

    v_cmp_gt_i32 s[78:79], s64, v4
    v_cmp_gt_i32 s[80:81], s64, v5
    s_add_u32 s64, s64, s65
    v_add_f32_dpp v86, v97, v96 row_ror:8 row_mask:0xf bank_mask:0x3
    v_add_f32_dpp v87, v99, v98 row_ror:8 row_mask:0xf bank_mask:0x3
    s_nop 0
    v_add_f32_dpp v86, v100, v101 row_ror:8 row_mask:0xf bank_mask:0xc
    v_add_f32_dpp v87, v102, v103 row_ror:8 row_mask:0xf bank_mask:0xc
    v_cndmask_b32 v86, v10, v86, s[78:79]
    v_cndmask_b32 v87, v10, v87, s[80:81]
    v_max3_f32 v16, v16, v86, v87

KEND:
    v_cmp_ne_u32 vcc, v31, v30
    s_cbranch_vccnz SLOW
    s_mov_b32 s40, s14
    s_mov_b32 s41, s15
    s_mov_b32 s42, 0x40000
    s_mov_b32 s43, 0x00020000
    s_mov_b32 s36, s18
    s_mov_b32 s37, s19
    s_mov_b32 s38, 0x10040000
    s_mov_b32 s39, 0x00020000

    s_mov_b32 s62, 0x05040100
    s_mov_b32 s63, 0x07060302
    s_mov_b32 s61, 0x3e0293ee

    s_mov_b32 s54, 0xffff0000

    s_mov_b32 s72, 65536
    s_waitcnt lgkmcnt(0)
    s_add_u32 s82, s82, 0x1010101
    s_add_u32 s83, s83, 0x1010101
    v_mov_b32 v18, s82
    v_mov_b32 v19, s83

    s_add_u32 s3, s3, 0x1010101
    v_mov_b32 v20, s3

    s_lshr_b32 s70, s75, 3
    s_mul_i32 s70, s70, 278528
    s_add_u32 s70, s70, 4096

    s_and_b32 s71, s75, 3
    s_lshl_b32 s67, s71, 12
    s_add_u32 s67, s67, s70
    s_lshl_b32 s73, s71, 11
    s_and_b32 s71, s75, 4
    s_lshl_b32 s70, s71, 9
    s_add_u32 s67, s67, s70
    s_lshl_b32 s70, s71, 5
    s_add_u32 s73, s73, s70
    s_min_u32 s74, s56, 1
    s_lshl_b32 s74, s74, 8
    s_add_u32 s67, s67, s74
    s_lshl_b32 s70, s56, 8
    s_add_u32 s67, s67, s70
    s_lshl_b32 s70, s56, 5
    s_add_u32 s73, s73, s70
    s_lshr_b32 s70, s75, 3
    s_lshl_b32 s70, s70, 13
    s_add_u32 s73, s73, s70
    v_lshrrev_b32 v22, 5, v1
    v_and_b32 v24, 1, v29
    s_movk_i32 s70, 17408

    v_mul_u32_u24 v25, s70, v29
    s_mov_b32 s71, s56
    s_lshl_b32 s70, s56, 7
    s_mulk_i32 s71, 192
    s_sub_u32 s71, 1536, s71
    s_sub_u32 s71, s71, s74
    v_lshl_add_u32 v21, v28, 2, v25
    v_add_u32 v21, s71, v21
    v_lshl_add_u32 v25, v28, 4, v25

    v_add_u32 v26, 0, v29
    v_cmp_gt_u32 vcc, s68, v26
    v_add_u32 v26, 0x0, v25
    v_add_u32 v12, 0x0, v21
    v_cndmask_b32 v112, v11, v26, vcc
    v_cndmask_b32 v116, v11, v12, vcc
    v_cndmask_b32 v120, 0, v20, vcc

    v_add_u32 v26, 4, v29
    v_cmp_gt_u32 vcc, s68, v26
    v_add_u32 v26, 0x11000, v25
    v_add_u32 v12, 0x11000, v21
    v_cndmask_b32 v113, v11, v26, vcc
    v_cndmask_b32 v117, v11, v12, vcc
    v_cndmask_b32 v121, 0, v20, vcc

    v_add_u32 v26, 8, v29
    v_cmp_gt_u32 vcc, s68, v26
    v_add_u32 v26, 0x22000, v25
    v_add_u32 v12, 0x22000, v21
    v_cndmask_b32 v114, v11, v26, vcc
    v_cndmask_b32 v118, v11, v12, vcc
    v_cndmask_b32 v122, 0, v20, vcc

    v_add_u32 v26, 12, v29
    v_cmp_gt_u32 vcc, s68, v26
    v_add_u32 v26, 0x33000, v25
    v_add_u32 v12, 0x33000, v21
    v_cndmask_b32 v115, v11, v26, vcc
    v_cndmask_b32 v119, v11, v12, vcc
    v_cndmask_b32 v123, 0, v20, vcc

    v_lshlrev_b32 v8, 8, v27
    v_lshl_add_u32 v8, v22, 4, v8
    v_lshl_add_u32 v8, v23, 3, v8
    v_lshl_add_u32 v8, v24, 2, v8
    v_lshlrev_b32 v9, 6, v27
    v_lshl_add_u32 v9, v29, 4, v9
    v_lshlrev_b32 v12, 2, v1

    s_cmp_eq_u32 s60, 0
    s_cbranch_scc1 IDLE

    v_lshlrev_b32 v6, 4, v1
    v_min_u32 v26, 1, v29
    v_lshl_add_u32 v6, v26, 8, v6

    v_cmp_gt_u32 vcc, 8, v1
    v_lshlrev_b32 v26, 4, v1
    s_lshl_b32 s66, s57, 4
    s_add_u32 s66, s66, s32
    s_mul_i32 s66, s66, 17408
    s_add_u32 s71, s66, s70
    s_add_u32 s71, s71, 20992
    v_cndmask_b32 v7, v11, v26, vcc
    s_lshl_b32 s70, s56, 12
    s_add_u32 s66, s66, s70
    s_add_u32 s66, s66, 4096

    v_mov_b32 v40, 0
    v_mov_b32 v41, 0
    v_mov_b32 v42, 0
    v_mov_b32 v43, 0
    v_mov_b32 v44, 0
    v_mov_b32 v45, 0
    v_mov_b32 v46, 0
    v_mov_b32 v47, 0
    v_mov_b32 v48, 0
    v_mov_b32 v49, 0
    v_mov_b32 v50, 0
    v_mov_b32 v51, 0
    v_mov_b32 v52, 0
    v_mov_b32 v53, 0
    v_mov_b32 v54, 0
    v_mov_b32 v55, 0
    v_mov_b32 v88, 0
    v_mov_b32 v89, 0
    v_mov_b32 v90, 0
    v_mov_b32 v91, 0
    v_mov_b32 v92, 0
    v_mov_b32 v93, 0
    v_mov_b32 v94, 0
    v_mov_b32 v95, 0

    s_nop 1
    v_max_f32_dpp v16, v16, v16 row_ror:8 row_mask:0xf bank_mask:0xf
    v_mov_b32 v20, v16
    s_nop 1
    v_permlane16_swap_b32 v16, v20
    s_branch SKIP4
PAD4:
    s_branch PAD5
SKIP4:
    v_max_f32 v16, v16, v20
    v_mov_b32 v20, v16
    s_nop 1
    v_permlane32_swap_b32 v16, v20
    v_max_f32 v16, v16, v20

    v_mul_f32 v16, s61, v16
    v_fma_f32 v56, v56, s61, -v16
    v_fma_f32 v57, v57, s61, -v16
    v_fma_f32 v58, v58, s61, -v16
    v_fma_f32 v59, v59, s61, -v16
    v_fma_f32 v60, v60, s61, -v16
    v_fma_f32 v61, v61, s61, -v16
    v_fma_f32 v62, v62, s61, -v16
    v_fma_f32 v63, v63, s61, -v16
    v_fma_f32 v64, v64, s61, -v16
    v_fma_f32 v65, v65, s61, -v16
    v_fma_f32 v66, v66, s61, -v16
    v_fma_f32 v67, v67, s61, -v16
    v_fma_f32 v68, v68, s61, -v16
    v_fma_f32 v69, v69, s61, -v16
    v_fma_f32 v70, v70, s61, -v16
    v_fma_f32 v71, v71, s61, -v16
    v_fma_f32 v72, v72, s61, -v16
    v_fma_f32 v73, v73, s61, -v16
    v_fma_f32 v74, v74, s61, -v16
    v_fma_f32 v75, v75, s61, -v16
    v_fma_f32 v76, v76, s61, -v16
    v_fma_f32 v77, v77, s61, -v16
    v_fma_f32 v78, v78, s61, -v16
    v_fma_f32 v79, v79, s61, -v16
    v_fma_f32 v80, v80, s61, -v16
    v_fma_f32 v81, v81, s61, -v16
    v_fma_f32 v82, v82, s61, -v16
    v_fma_f32 v83, v83, s61, -v16
    v_fma_f32 v84, v84, s61, -v16
    v_fma_f32 v85, v85, s61, -v16
    v_fma_f32 v86, v86, s61, -v16
    v_fma_f32 v87, v87, s61, -v16
    v_exp_f32 v56, v56
    v_exp_f32 v57, v57
    v_exp_f32 v58, v58
    v_exp_f32 v59, v59
    v_exp_f32 v60, v60
    v_exp_f32 v61, v61
    v_exp_f32 v62, v62
    v_exp_f32 v63, v63
    v_exp_f32 v64, v64
    v_exp_f32 v65, v65
    v_exp_f32 v66, v66
    v_exp_f32 v67, v67
    v_exp_f32 v68, v68
    v_exp_f32 v69, v69
    v_exp_f32 v70, v70
    v_exp_f32 v71, v71
    v_exp_f32 v72, v72
    v_exp_f32 v73, v73
    v_exp_f32 v74, v74
    v_exp_f32 v75, v75
    v_exp_f32 v76, v76
    v_exp_f32 v77, v77
    v_exp_f32 v78, v78
    v_exp_f32 v79, v79
    v_exp_f32 v80, v80
    v_exp_f32 v81, v81
    v_exp_f32 v82, v82
    v_exp_f32 v83, v83
    v_exp_f32 v84, v84
    v_exp_f32 v85, v85
    v_exp_f32 v86, v86
    v_exp_f32 v87, v87
    v_add_f32 v17, v56, v57
    v_add_f32 v21, v58, v59
    v_add_f32 v17, v17, v60
    v_add_f32 v21, v21, v61
    v_add_f32 v17, v17, v62
    v_add_f32 v21, v21, v63
    v_add_f32 v17, v17, v64
    v_add_f32 v21, v21, v65
    v_add_f32 v17, v17, v66
    v_add_f32 v21, v21, v67
    v_add_f32 v17, v17, v68
    v_add_f32 v21, v21, v69
    v_add_f32 v17, v17, v70
    v_add_f32 v21, v21, v71
    v_add_f32 v17, v17, v72
    v_add_f32 v21, v21, v73
    v_add_f32 v17, v17, v74
    v_add_f32 v21, v21, v75
    v_add_f32 v17, v17, v76
    v_add_f32 v21, v21, v77
    v_add_f32 v17, v17, v78
    v_add_f32 v21, v21, v79
    v_add_f32 v17, v17, v80
    v_add_f32 v21, v21, v81
    v_add_f32 v17, v17, v82
    v_add_f32 v21, v21, v83
    v_add_f32 v17, v17, v84
    v_add_f32 v21, v21, v85
    v_add_f32 v17, v17, v86
    v_add_f32 v21, v21, v87
    v_add_f32 v17, v17, v21

    s_nop 1
    v_add_f32_dpp v17, v17, v17 row_ror:8 row_mask:0xf bank_mask:0xf
    v_mov_b32 v20, v17
    s_nop 1
    v_permlane16_swap_b32 v17, v20
    v_add_f32 v17, v17, v20
    v_mov_b32 v20, v17
    s_nop 1
    v_permlane32_swap_b32 v17, v20
    v_add_f32 v17, v17, v20

    buffer_store_dwordx4 v[16:19], v7, s[36:39], s71 offen sc1
    v_cvt_pk_bf16_f32 v56, v56, v57
    v_cvt_pk_bf16_f32 v57, v58, v59
    v_cvt_pk_bf16_f32 v58, v60, v61
    v_cvt_pk_bf16_f32 v59, v62, v63
    v_cvt_pk_bf16_f32 v60, v64, v65
    v_cvt_pk_bf16_f32 v61, v66, v67
    v_cvt_pk_bf16_f32 v62, v68, v69
    v_cvt_pk_bf16_f32 v63, v70, v71
    v_cvt_pk_bf16_f32 v64, v72, v73
    v_cvt_pk_bf16_f32 v65, v74, v75
    v_cvt_pk_bf16_f32 v66, v76, v77
    v_cvt_pk_bf16_f32 v67, v78, v79
    v_cvt_pk_bf16_f32 v68, v80, v81
    v_cvt_pk_bf16_f32 v69, v82, v83
    v_cvt_pk_bf16_f32 v70, v84, v85
    v_cvt_pk_bf16_f32 v71, v86, v87
    s_nop 1

    v_mov_b32_dpp v88, v71 quad_perm:[0,1,2,3] row_mask:0xf bank_mask:0x3
    v_mov_b32_dpp v89, v71 row_ror:8 row_mask:0xf bank_mask:0x3
    v_mov_b32_dpp v90, v71 row_ror:8 row_mask:0xf bank_mask:0xc
    v_mov_b32_dpp v91, v71 quad_perm:[0,1,2,3] row_mask:0xf bank_mask:0xc

    s_waitcnt vmcnt(21)
    v_perm_b32 v96, v200, v192, s62
    v_perm_b32 v97, v204, v196, s62
    v_perm_b32 v98, v202, v194, s62
    v_perm_b32 v99, v206, v198, s62
    v_perm_b32 v100, v200, v192, s63
    v_perm_b32 v101, v204, v196, s63
    v_mfma_f32_16x16x32_bf16 v[40:43], v[96:99], v[88:91], v[40:43]
    v_perm_b32 v102, v202, v194, s63
    v_perm_b32 v103, v206, v198, s63
    v_perm_b32 v104, v201, v193, s62
    v_perm_b32 v105, v205, v197, s62
    v_mfma_f32_16x16x32_bf16 v[44:47], v[100:103], v[88:91], v[44:47]
    v_perm_b32 v106, v203, v195, s62
    v_perm_b32 v107, v207, v199, s62
    v_perm_b32 v108, v201, v193, s63
    v_perm_b32 v109, v205, v197, s63
    v_mfma_f32_16x16x32_bf16 v[48:51], v[104:107], v[88:91], v[48:51]
    v_perm_b32 v110, v203, v195, s63
    v_perm_b32 v111, v207, v199, s63
    s_cmp_eq_u32 s60, 1
    s_nop 0
    v_mfma_f32_16x16x32_bf16 v[52:55], v[108:111], v[88:91], v[52:55]
    s_cbranch_scc1 EPI
    v_readlane_b32 s49, v13, 8
    buffer_load_dwordx4 v[192:195], v3, s[24:27], s48 offen offset:0 nt
    buffer_load_dwordx4 v[196:199], v3, s[24:27], s48 offen offset:1024 nt
    buffer_load_dwordx4 v[200:203], v3, s[24:27], s48 offen offset:2048 nt
    buffer_load_dwordx4 v[204:207], v3, s[24:27], s48 offen offset:3072 nt

    v_mov_b32_dpp v92, v70 quad_perm:[0,1,2,3] row_mask:0xf bank_mask:0x3
    v_mov_b32_dpp v93, v70 row_ror:8 row_mask:0xf bank_mask:0x3
    v_mov_b32_dpp v94, v70 row_ror:8 row_mask:0xf bank_mask:0xc
    v_mov_b32_dpp v95, v70 quad_perm:[0,1,2,3] row_mask:0xf bank_mask:0xc

    s_waitcnt vmcnt(21)
    v_perm_b32 v96, v216, v208, s62
    v_perm_b32 v97, v220, v212, s62
    s_branch SKIP5
PAD5:
    s_branch PAD6
SKIP5:
    v_perm_b32 v98, v218, v210, s62
    v_perm_b32 v99, v222, v214, s62
    v_perm_b32 v100, v216, v208, s63
    v_perm_b32 v101, v220, v212, s63
    v_mfma_f32_16x16x32_bf16 v[40:43], v[96:99], v[92:95], v[40:43]
    v_perm_b32 v102, v218, v210, s63
    v_perm_b32 v103, v222, v214, s63
    v_perm_b32 v104, v217, v209, s62
    v_perm_b32 v105, v221, v213, s62
    v_mfma_f32_16x16x32_bf16 v[44:47], v[100:103], v[92:95], v[44:47]
    v_perm_b32 v106, v219, v211, s62
    v_perm_b32 v107, v223, v215, s62
    v_perm_b32 v108, v217, v209, s63
    v_perm_b32 v109, v221, v213, s63
    v_mfma_f32_16x16x32_bf16 v[48:51], v[104:107], v[92:95], v[48:51]
    v_perm_b32 v110, v219, v211, s63
    v_perm_b32 v111, v223, v215, s63
    s_cmp_eq_u32 s60, 2
    s_nop 0
    v_mfma_f32_16x16x32_bf16 v[52:55], v[108:111], v[92:95], v[52:55]
    s_cbranch_scc1 EPI
    v_readlane_b32 s48, v13, 7
    buffer_load_dwordx4 v[208:211], v3, s[24:27], s49 offen offset:0 nt
    buffer_load_dwordx4 v[212:215], v3, s[24:27], s49 offen offset:1024 nt
    buffer_load_dwordx4 v[216:219], v3, s[24:27], s49 offen offset:2048 nt
    buffer_load_dwordx4 v[220:223], v3, s[24:27], s49 offen offset:3072 nt

    v_mov_b32_dpp v88, v69 quad_perm:[0,1,2,3] row_mask:0xf bank_mask:0x3
    v_mov_b32_dpp v89, v69 row_ror:8 row_mask:0xf bank_mask:0x3
    v_mov_b32_dpp v90, v69 row_ror:8 row_mask:0xf bank_mask:0xc
    v_mov_b32_dpp v91, v69 quad_perm:[0,1,2,3] row_mask:0xf bank_mask:0xc

    s_waitcnt vmcnt(21)
    v_perm_b32 v96, v136, v128, s62
    v_perm_b32 v97, v140, v132, s62
    v_perm_b32 v98, v138, v130, s62
    v_perm_b32 v99, v142, v134, s62
    v_perm_b32 v100, v136, v128, s63
    v_perm_b32 v101, v140, v132, s63
    v_mfma_f32_16x16x32_bf16 v[40:43], v[96:99], v[88:91], v[40:43]
    v_perm_b32 v102, v138, v130, s63
    v_perm_b32 v103, v142, v134, s63
    v_perm_b32 v104, v137, v129, s62
    v_perm_b32 v105, v141, v133, s62
    v_mfma_f32_16x16x32_bf16 v[44:47], v[100:103], v[88:91], v[44:47]
    v_perm_b32 v106, v139, v131, s62
    v_perm_b32 v107, v143, v135, s62
    v_perm_b32 v108, v137, v129, s63
    v_perm_b32 v109, v141, v133, s63
    v_mfma_f32_16x16x32_bf16 v[48:51], v[104:107], v[88:91], v[48:51]
    v_perm_b32 v110, v139, v131, s63
    v_perm_b32 v111, v143, v135, s63
    s_cmp_eq_u32 s60, 3
    s_nop 0
    v_mfma_f32_16x16x32_bf16 v[52:55], v[108:111], v[88:91], v[52:55]
    s_cbranch_scc1 EPI
    v_readlane_b32 s49, v13, 6
    buffer_load_dwordx4 v[128:131], v3, s[24:27], s48 offen offset:0 nt
    buffer_load_dwordx4 v[132:135], v3, s[24:27], s48 offen offset:1024 nt
    buffer_load_dwordx4 v[136:139], v3, s[24:27], s48 offen offset:2048 nt
    buffer_load_dwordx4 v[140:143], v3, s[24:27], s48 offen offset:3072 nt

    v_mov_b32_dpp v92, v68 quad_perm:[0,1,2,3] row_mask:0xf bank_mask:0x3
    v_mov_b32_dpp v93, v68 row_ror:8 row_mask:0xf bank_mask:0x3
    v_mov_b32_dpp v94, v68 row_ror:8 row_mask:0xf bank_mask:0xc
    v_mov_b32_dpp v95, v68 quad_perm:[0,1,2,3] row_mask:0xf bank_mask:0xc

    s_waitcnt vmcnt(21)
    v_perm_b32 v96, v152, v144, s62
    v_perm_b32 v97, v156, v148, s62
    v_perm_b32 v98, v154, v146, s62
    v_perm_b32 v99, v158, v150, s62
    v_perm_b32 v100, v152, v144, s63
    v_perm_b32 v101, v156, v148, s63
    v_mfma_f32_16x16x32_bf16 v[40:43], v[96:99], v[92:95], v[40:43]
    v_perm_b32 v102, v154, v146, s63
    v_perm_b32 v103, v158, v150, s63
    v_perm_b32 v104, v153, v145, s62
    v_perm_b32 v105, v157, v149, s62
    v_mfma_f32_16x16x32_bf16 v[44:47], v[100:103], v[92:95], v[44:47]
    v_perm_b32 v106, v155, v147, s62
    v_perm_b32 v107, v159, v151, s62
    v_perm_b32 v108, v153, v145, s63
    v_perm_b32 v109, v157, v149, s63
    v_mfma_f32_16x16x32_bf16 v[48:51], v[104:107], v[92:95], v[48:51]
    v_perm_b32 v110, v155, v147, s63
    v_perm_b32 v111, v159, v151, s63
    s_cmp_eq_u32 s60, 4
    s_nop 0
    v_mfma_f32_16x16x32_bf16 v[52:55], v[108:111], v[92:95], v[52:55]
    s_cbranch_scc1 EPI
    v_readlane_b32 s48, v13, 5
    buffer_load_dwordx4 v[144:147], v3, s[24:27], s49 offen offset:0 nt
    buffer_load_dwordx4 v[148:151], v3, s[24:27], s49 offen offset:1024 nt
    buffer_load_dwordx4 v[152:155], v3, s[24:27], s49 offen offset:2048 nt
    buffer_load_dwordx4 v[156:159], v3, s[24:27], s49 offen offset:3072 nt

    v_mov_b32_dpp v88, v67 quad_perm:[0,1,2,3] row_mask:0xf bank_mask:0x3
    v_mov_b32_dpp v89, v67 row_ror:8 row_mask:0xf bank_mask:0x3
    v_mov_b32_dpp v90, v67 row_ror:8 row_mask:0xf bank_mask:0xc
    v_mov_b32_dpp v91, v67 quad_perm:[0,1,2,3] row_mask:0xf bank_mask:0xc

    s_waitcnt vmcnt(21)
    v_perm_b32 v96, v168, v160, s62
    v_perm_b32 v97, v172, v164, s62
    v_perm_b32 v98, v170, v162, s62
    v_perm_b32 v99, v174, v166, s62
    v_perm_b32 v100, v168, v160, s63
    v_perm_b32 v101, v172, v164, s63
    v_mfma_f32_16x16x32_bf16 v[40:43], v[96:99], v[88:91], v[40:43]
    v_perm_b32 v102, v170, v162, s63
    v_perm_b32 v103, v174, v166, s63
    v_perm_b32 v104, v169, v161, s62
    v_perm_b32 v105, v173, v165, s62
    v_mfma_f32_16x16x32_bf16 v[44:47], v[100:103], v[88:91], v[44:47]
    v_perm_b32 v106, v171, v163, s62
    v_perm_b32 v107, v175, v167, s62
    v_perm_b32 v108, v169, v161, s63
    v_perm_b32 v109, v173, v165, s63
    v_mfma_f32_16x16x32_bf16 v[48:51], v[104:107], v[88:91], v[48:51]
    v_perm_b32 v110, v171, v163, s63
    v_perm_b32 v111, v175, v167, s63
    s_cmp_eq_u32 s60, 5
    s_nop 0
    v_mfma_f32_16x16x32_bf16 v[52:55], v[108:111], v[88:91], v[52:55]
    s_cbranch_scc1 EPI
    v_readlane_b32 s49, v13, 4
    buffer_load_dwordx4 v[160:163], v3, s[24:27], s48 offen offset:0 nt
    buffer_load_dwordx4 v[164:167], v3, s[24:27], s48 offen offset:1024 nt
    buffer_load_dwordx4 v[168:171], v3, s[24:27], s48 offen offset:2048 nt
    buffer_load_dwordx4 v[172:175], v3, s[24:27], s48 offen offset:3072 nt

    v_mov_b32_dpp v92, v66 quad_perm:[0,1,2,3] row_mask:0xf bank_mask:0x3
    v_mov_b32_dpp v93, v66 row_ror:8 row_mask:0xf bank_mask:0x3
    v_mov_b32_dpp v94, v66 row_ror:8 row_mask:0xf bank_mask:0xc
    v_mov_b32_dpp v95, v66 quad_perm:[0,1,2,3] row_mask:0xf bank_mask:0xc

    s_waitcnt vmcnt(21)
    v_perm_b32 v96, v184, v176, s62
    v_perm_b32 v97, v188, v180, s62
    v_perm_b32 v98, v186, v178, s62
    v_perm_b32 v99, v190, v182, s62
    v_perm_b32 v100, v184, v176, s63
    s_branch SKIP6
PAD6:
    s_branch PAD7
SKIP6:
    v_perm_b32 v101, v188, v180, s63
    v_mfma_f32_16x16x32_bf16 v[40:43], v[96:99], v[92:95], v[40:43]
    v_perm_b32 v102, v186, v178, s63
    v_perm_b32 v103, v190, v182, s63
    v_perm_b32 v104, v185, v177, s62
    v_perm_b32 v105, v189, v181, s62
    v_mfma_f32_16x16x32_bf16 v[44:47], v[100:103], v[92:95], v[44:47]
    v_perm_b32 v106, v187, v179, s62
    v_perm_b32 v107, v191, v183, s62
    v_perm_b32 v108, v185, v177, s63
    v_perm_b32 v109, v189, v181, s63
    v_mfma_f32_16x16x32_bf16 v[48:51], v[104:107], v[92:95], v[48:51]
    v_perm_b32 v110, v187, v179, s63
    v_perm_b32 v111, v191, v183, s63
    s_cmp_eq_u32 s60, 6
    s_nop 0
    v_mfma_f32_16x16x32_bf16 v[52:55], v[108:111], v[92:95], v[52:55]
    s_cbranch_scc1 EPI
    v_readlane_b32 s48, v13, 3
    buffer_load_dwordx4 v[176:179], v3, s[24:27], s49 offen offset:0 nt
    buffer_load_dwordx4 v[180:183], v3, s[24:27], s49 offen offset:1024 nt
    buffer_load_dwordx4 v[184:187], v3, s[24:27], s49 offen offset:2048 nt
    buffer_load_dwordx4 v[188:191], v3, s[24:27], s49 offen offset:3072 nt

    v_mov_b32_dpp v88, v65 quad_perm:[0,1,2,3] row_mask:0xf bank_mask:0x3
    v_mov_b32_dpp v89, v65 row_ror:8 row_mask:0xf bank_mask:0x3
    v_mov_b32_dpp v90, v65 row_ror:8 row_mask:0xf bank_mask:0xc
    v_mov_b32_dpp v91, v65 quad_perm:[0,1,2,3] row_mask:0xf bank_mask:0xc

    s_waitcnt vmcnt(20)
    v_perm_b32 v96, v200, v192, s62
    v_perm_b32 v97, v204, v196, s62
    v_perm_b32 v98, v202, v194, s62
    v_perm_b32 v99, v206, v198, s62
    v_perm_b32 v100, v200, v192, s63
    v_perm_b32 v101, v204, v196, s63
    v_mfma_f32_16x16x32_bf16 v[40:43], v[96:99], v[88:91], v[40:43]
    v_perm_b32 v102, v202, v194, s63
    v_perm_b32 v103, v206, v198, s63
    v_perm_b32 v104, v201, v193, s62
    v_perm_b32 v105, v205, v197, s62
    v_mfma_f32_16x16x32_bf16 v[44:47], v[100:103], v[88:91], v[44:47]
    v_perm_b32 v106, v203, v195, s62
    v_perm_b32 v107, v207, v199, s62
    v_perm_b32 v108, v201, v193, s63
    v_perm_b32 v109, v205, v197, s63
    v_mfma_f32_16x16x32_bf16 v[48:51], v[104:107], v[88:91], v[48:51]
    v_perm_b32 v110, v203, v195, s63
    v_perm_b32 v111, v207, v199, s63
    s_cmp_eq_u32 s60, 7
    s_nop 0
    v_mfma_f32_16x16x32_bf16 v[52:55], v[108:111], v[88:91], v[52:55]
    s_cbranch_scc1 EPI
    v_readlane_b32 s49, v13, 2
    buffer_load_dwordx4 v[192:195], v3, s[24:27], s48 offen offset:0 nt
    buffer_load_dwordx4 v[196:199], v3, s[24:27], s48 offen offset:1024 nt
    buffer_load_dwordx4 v[200:203], v3, s[24:27], s48 offen offset:2048 nt
    buffer_load_dwordx4 v[204:207], v3, s[24:27], s48 offen offset:3072 nt

    v_mov_b32_dpp v92, v64 quad_perm:[0,1,2,3] row_mask:0xf bank_mask:0x3
    v_mov_b32_dpp v93, v64 row_ror:8 row_mask:0xf bank_mask:0x3
    v_mov_b32_dpp v94, v64 row_ror:8 row_mask:0xf bank_mask:0xc
    v_mov_b32_dpp v95, v64 quad_perm:[0,1,2,3] row_mask:0xf bank_mask:0xc

    s_waitcnt vmcnt(20)
    v_perm_b32 v96, v216, v208, s62
    v_perm_b32 v97, v220, v212, s62
    v_perm_b32 v98, v218, v210, s62
    v_perm_b32 v99, v222, v214, s62
    v_perm_b32 v100, v216, v208, s63
    v_perm_b32 v101, v220, v212, s63
    v_mfma_f32_16x16x32_bf16 v[40:43], v[96:99], v[92:95], v[40:43]
    v_perm_b32 v102, v218, v210, s63
    v_perm_b32 v103, v222, v214, s63
    v_perm_b32 v104, v217, v209, s62
    v_perm_b32 v105, v221, v213, s62
    v_mfma_f32_16x16x32_bf16 v[44:47], v[100:103], v[92:95], v[44:47]
    v_perm_b32 v106, v219, v211, s62
    v_perm_b32 v107, v223, v215, s62
    v_perm_b32 v108, v217, v209, s63
    v_perm_b32 v109, v221, v213, s63
    v_mfma_f32_16x16x32_bf16 v[48:51], v[104:107], v[92:95], v[48:51]
    v_perm_b32 v110, v219, v211, s63
    v_perm_b32 v111, v223, v215, s63
    s_cmp_eq_u32 s60, 8
    s_nop 0
    v_mfma_f32_16x16x32_bf16 v[52:55], v[108:111], v[92:95], v[52:55]
    s_cbranch_scc1 EPI
    v_readlane_b32 s48, v13, 1
    buffer_load_dwordx4 v[208:211], v3, s[24:27], s49 offen offset:0 nt
    buffer_load_dwordx4 v[212:215], v3, s[24:27], s49 offen offset:1024 nt
    buffer_load_dwordx4 v[216:219], v3, s[24:27], s49 offen offset:2048 nt
    buffer_load_dwordx4 v[220:223], v3, s[24:27], s49 offen offset:3072 nt

    v_mov_b32_dpp v88, v63 quad_perm:[0,1,2,3] row_mask:0xf bank_mask:0x3
    v_mov_b32_dpp v89, v63 row_ror:8 row_mask:0xf bank_mask:0x3
    v_mov_b32_dpp v90, v63 row_ror:8 row_mask:0xf bank_mask:0xc
    v_mov_b32_dpp v91, v63 quad_perm:[0,1,2,3] row_mask:0xf bank_mask:0xc

    s_waitcnt vmcnt(20)
    v_perm_b32 v96, v136, v128, s62
    v_perm_b32 v97, v140, v132, s62
    v_perm_b32 v98, v138, v130, s62
    v_perm_b32 v99, v142, v134, s62
    v_perm_b32 v100, v136, v128, s63
    v_perm_b32 v101, v140, v132, s63
    v_mfma_f32_16x16x32_bf16 v[40:43], v[96:99], v[88:91], v[40:43]
    v_perm_b32 v102, v138, v130, s63
    v_perm_b32 v103, v142, v134, s63
    v_perm_b32 v104, v137, v129, s62
    v_perm_b32 v105, v141, v133, s62
    v_mfma_f32_16x16x32_bf16 v[44:47], v[100:103], v[88:91], v[44:47]
    v_perm_b32 v106, v139, v131, s62
    v_perm_b32 v107, v143, v135, s62
    v_perm_b32 v108, v137, v129, s63
    v_perm_b32 v109, v141, v133, s63
    v_mfma_f32_16x16x32_bf16 v[48:51], v[104:107], v[88:91], v[48:51]
    v_perm_b32 v110, v139, v131, s63
    v_perm_b32 v111, v143, v135, s63
    s_cmp_eq_u32 s60, 9
    s_nop 0
    v_mfma_f32_16x16x32_bf16 v[52:55], v[108:111], v[88:91], v[52:55]
    s_cbranch_scc1 EPI
    v_readlane_b32 s49, v13, 0
    buffer_load_dwordx4 v[128:131], v3, s[24:27], s48 offen offset:0 nt
    buffer_load_dwordx4 v[132:135], v3, s[24:27], s48 offen offset:1024 nt
    buffer_load_dwordx4 v[136:139], v3, s[24:27], s48 offen offset:2048 nt
    buffer_load_dwordx4 v[140:143], v3, s[24:27], s48 offen offset:3072 nt

    v_mov_b32_dpp v92, v62 quad_perm:[0,1,2,3] row_mask:0xf bank_mask:0x3
    v_mov_b32_dpp v93, v62 row_ror:8 row_mask:0xf bank_mask:0x3
    v_mov_b32_dpp v94, v62 row_ror:8 row_mask:0xf bank_mask:0xc
    v_mov_b32_dpp v95, v62 quad_perm:[0,1,2,3] row_mask:0xf bank_mask:0xc

    s_waitcnt vmcnt(20)
    v_perm_b32 v96, v152, v144, s62
    v_perm_b32 v97, v156, v148, s62
    v_perm_b32 v98, v154, v146, s62
    v_perm_b32 v99, v158, v150, s62
    v_perm_b32 v100, v152, v144, s63
    v_perm_b32 v101, v156, v148, s63
    v_mfma_f32_16x16x32_bf16 v[40:43], v[96:99], v[92:95], v[40:43]
    v_perm_b32 v102, v154, v146, s63
    s_branch SKIP7
PAD7:
    s_branch PAD8
SKIP7:
    v_perm_b32 v103, v158, v150, s63
    v_perm_b32 v104, v153, v145, s62
    v_perm_b32 v105, v157, v149, s62
    v_mfma_f32_16x16x32_bf16 v[44:47], v[100:103], v[92:95], v[44:47]
    v_perm_b32 v106, v155, v147, s62
    v_perm_b32 v107, v159, v151, s62
    v_perm_b32 v108, v153, v145, s63
    v_perm_b32 v109, v157, v149, s63
    v_mfma_f32_16x16x32_bf16 v[48:51], v[104:107], v[92:95], v[48:51]
    v_perm_b32 v110, v155, v147, s63
    v_perm_b32 v111, v159, v151, s63
    s_cmp_eq_u32 s60, 10
    s_nop 0
    v_mfma_f32_16x16x32_bf16 v[52:55], v[108:111], v[92:95], v[52:55]
    s_cbranch_scc1 EPI
    buffer_load_dwordx4 v[144:147], v3, s[24:27], s49 offen offset:0 nt
    buffer_load_dwordx4 v[148:151], v3, s[24:27], s49 offen offset:1024 nt
    buffer_load_dwordx4 v[152:155], v3, s[24:27], s49 offen offset:2048 nt
    buffer_load_dwordx4 v[156:159], v3, s[24:27], s49 offen offset:3072 nt

    v_mov_b32_dpp v88, v61 quad_perm:[0,1,2,3] row_mask:0xf bank_mask:0x3
    v_mov_b32_dpp v89, v61 row_ror:8 row_mask:0xf bank_mask:0x3
    v_mov_b32_dpp v90, v61 row_ror:8 row_mask:0xf bank_mask:0xc
    v_mov_b32_dpp v91, v61 quad_perm:[0,1,2,3] row_mask:0xf bank_mask:0xc

    s_waitcnt vmcnt(20)
    v_perm_b32 v96, v168, v160, s62
    v_perm_b32 v97, v172, v164, s62
    v_perm_b32 v98, v170, v162, s62
    v_perm_b32 v99, v174, v166, s62
    v_perm_b32 v100, v168, v160, s63
    v_perm_b32 v101, v172, v164, s63
    v_mfma_f32_16x16x32_bf16 v[40:43], v[96:99], v[88:91], v[40:43]
    v_perm_b32 v102, v170, v162, s63
    v_perm_b32 v103, v174, v166, s63
    v_perm_b32 v104, v169, v161, s62
    v_perm_b32 v105, v173, v165, s62
    v_mfma_f32_16x16x32_bf16 v[44:47], v[100:103], v[88:91], v[44:47]
    v_perm_b32 v106, v171, v163, s62
    v_perm_b32 v107, v175, v167, s62
    v_perm_b32 v108, v169, v161, s63
    v_perm_b32 v109, v173, v165, s63
    v_mfma_f32_16x16x32_bf16 v[48:51], v[104:107], v[88:91], v[48:51]
    v_perm_b32 v110, v171, v163, s63
    v_perm_b32 v111, v175, v167, s63
    s_cmp_eq_u32 s60, 11
    s_nop 0
    v_mfma_f32_16x16x32_bf16 v[52:55], v[108:111], v[88:91], v[52:55]
    s_cbranch_scc1 EPI

    v_mov_b32_dpp v92, v60 quad_perm:[0,1,2,3] row_mask:0xf bank_mask:0x3
    v_mov_b32_dpp v93, v60 row_ror:8 row_mask:0xf bank_mask:0x3
    v_mov_b32_dpp v94, v60 row_ror:8 row_mask:0xf bank_mask:0xc
    v_mov_b32_dpp v95, v60 quad_perm:[0,1,2,3] row_mask:0xf bank_mask:0xc

    s_waitcnt vmcnt(16)
    v_perm_b32 v96, v184, v176, s62
    v_perm_b32 v97, v188, v180, s62
    v_perm_b32 v98, v186, v178, s62
    v_perm_b32 v99, v190, v182, s62
    v_perm_b32 v100, v184, v176, s63
    v_perm_b32 v101, v188, v180, s63
    v_mfma_f32_16x16x32_bf16 v[40:43], v[96:99], v[92:95], v[40:43]
    v_perm_b32 v102, v186, v178, s63
    v_perm_b32 v103, v190, v182, s63
    v_perm_b32 v104, v185, v177, s62
    v_perm_b32 v105, v189, v181, s62
    v_mfma_f32_16x16x32_bf16 v[44:47], v[100:103], v[92:95], v[44:47]
    v_perm_b32 v106, v187, v179, s62
    v_perm_b32 v107, v191, v183, s62
    v_perm_b32 v108, v185, v177, s63
    v_perm_b32 v109, v189, v181, s63
    v_mfma_f32_16x16x32_bf16 v[48:51], v[104:107], v[92:95], v[48:51]
    v_perm_b32 v110, v187, v179, s63
    v_perm_b32 v111, v191, v183, s63
    s_cmp_eq_u32 s60, 12
    s_nop 0
    v_mfma_f32_16x16x32_bf16 v[52:55], v[108:111], v[92:95], v[52:55]
    s_cbranch_scc1 EPI

    v_mov_b32_dpp v88, v59 quad_perm:[0,1,2,3] row_mask:0xf bank_mask:0x3
    v_mov_b32_dpp v89, v59 row_ror:8 row_mask:0xf bank_mask:0x3
    v_mov_b32_dpp v90, v59 row_ror:8 row_mask:0xf bank_mask:0xc
    v_mov_b32_dpp v91, v59 quad_perm:[0,1,2,3] row_mask:0xf bank_mask:0xc

    s_waitcnt vmcnt(12)
    v_perm_b32 v96, v200, v192, s62
    v_perm_b32 v97, v204, v196, s62
    v_perm_b32 v98, v202, v194, s62
    v_perm_b32 v99, v206, v198, s62
    v_perm_b32 v100, v200, v192, s63
    v_perm_b32 v101, v204, v196, s63
    v_mfma_f32_16x16x32_bf16 v[40:43], v[96:99], v[88:91], v[40:43]
    v_perm_b32 v102, v202, v194, s63
    v_perm_b32 v103, v206, v198, s63
    v_perm_b32 v104, v201, v193, s62
    v_perm_b32 v105, v205, v197, s62
    v_mfma_f32_16x16x32_bf16 v[44:47], v[100:103], v[88:91], v[44:47]
    v_perm_b32 v106, v203, v195, s62
    v_perm_b32 v107, v207, v199, s62
    v_perm_b32 v108, v201, v193, s63
    v_perm_b32 v109, v205, v197, s63
    v_mfma_f32_16x16x32_bf16 v[48:51], v[104:107], v[88:91], v[48:51]
    v_perm_b32 v110, v203, v195, s63
    v_perm_b32 v111, v207, v199, s63
    s_cmp_eq_u32 s60, 13
    s_nop 0
    v_mfma_f32_16x16x32_bf16 v[52:55], v[108:111], v[88:91], v[52:55]
    s_cbranch_scc1 EPI

    v_mov_b32_dpp v92, v58 quad_perm:[0,1,2,3] row_mask:0xf bank_mask:0x3
    v_mov_b32_dpp v93, v58 row_ror:8 row_mask:0xf bank_mask:0x3
    v_mov_b32_dpp v94, v58 row_ror:8 row_mask:0xf bank_mask:0xc
    v_mov_b32_dpp v95, v58 quad_perm:[0,1,2,3] row_mask:0xf bank_mask:0xc

    s_waitcnt vmcnt(8)
    v_perm_b32 v96, v216, v208, s62
    v_perm_b32 v97, v220, v212, s62
    v_perm_b32 v98, v218, v210, s62
    v_perm_b32 v99, v222, v214, s62
    v_perm_b32 v100, v216, v208, s63
    v_perm_b32 v101, v220, v212, s63
    v_mfma_f32_16x16x32_bf16 v[40:43], v[96:99], v[92:95], v[40:43]
    v_perm_b32 v102, v218, v210, s63
    v_perm_b32 v103, v222, v214, s63
    v_perm_b32 v104, v217, v209, s62
    v_perm_b32 v105, v221, v213, s62
    v_mfma_f32_16x16x32_bf16 v[44:47], v[100:103], v[92:95], v[44:47]
    v_perm_b32 v106, v219, v211, s62
    v_perm_b32 v107, v223, v215, s62
    v_perm_b32 v108, v217, v209, s63
    v_perm_b32 v109, v221, v213, s63
    v_mfma_f32_16x16x32_bf16 v[48:51], v[104:107], v[92:95], v[48:51]
    v_perm_b32 v110, v219, v211, s63
    v_perm_b32 v111, v223, v215, s63
    s_cmp_eq_u32 s60, 14
    s_nop 0
    v_mfma_f32_16x16x32_bf16 v[52:55], v[108:111], v[92:95], v[52:55]
    s_cbranch_scc1 EPI

    v_mov_b32_dpp v88, v57 quad_perm:[0,1,2,3] row_mask:0xf bank_mask:0x3
    v_mov_b32_dpp v89, v57 row_ror:8 row_mask:0xf bank_mask:0x3
    v_mov_b32_dpp v90, v57 row_ror:8 row_mask:0xf bank_mask:0xc
    v_mov_b32_dpp v91, v57 quad_perm:[0,1,2,3] row_mask:0xf bank_mask:0xc

    s_waitcnt vmcnt(4)
    v_perm_b32 v96, v136, v128, s62
    s_branch SKIP8
PAD8:
    s_branch PAD9
SKIP8:
    v_perm_b32 v97, v140, v132, s62
    v_perm_b32 v98, v138, v130, s62
    v_perm_b32 v99, v142, v134, s62
    v_perm_b32 v100, v136, v128, s63
    v_perm_b32 v101, v140, v132, s63
    v_mfma_f32_16x16x32_bf16 v[40:43], v[96:99], v[88:91], v[40:43]
    v_perm_b32 v102, v138, v130, s63
    v_perm_b32 v103, v142, v134, s63
    v_perm_b32 v104, v137, v129, s62
    v_perm_b32 v105, v141, v133, s62
    v_mfma_f32_16x16x32_bf16 v[44:47], v[100:103], v[88:91], v[44:47]
    v_perm_b32 v106, v139, v131, s62
    v_perm_b32 v107, v143, v135, s62
    v_perm_b32 v108, v137, v129, s63
    v_perm_b32 v109, v141, v133, s63
    v_mfma_f32_16x16x32_bf16 v[48:51], v[104:107], v[88:91], v[48:51]
    v_perm_b32 v110, v139, v131, s63
    v_perm_b32 v111, v143, v135, s63
    s_cmp_eq_u32 s60, 15
    s_nop 0
    v_mfma_f32_16x16x32_bf16 v[52:55], v[108:111], v[88:91], v[52:55]
    s_cbranch_scc1 EPI

    v_mov_b32_dpp v92, v56 quad_perm:[0,1,2,3] row_mask:0xf bank_mask:0x3
    v_mov_b32_dpp v93, v56 row_ror:8 row_mask:0xf bank_mask:0x3
    v_mov_b32_dpp v94, v56 row_ror:8 row_mask:0xf bank_mask:0xc
    v_mov_b32_dpp v95, v56 quad_perm:[0,1,2,3] row_mask:0xf bank_mask:0xc

    s_waitcnt vmcnt(0)
    v_perm_b32 v96, v152, v144, s62
    v_perm_b32 v97, v156, v148, s62
    v_perm_b32 v98, v154, v146, s62
    v_perm_b32 v99, v158, v150, s62
    v_perm_b32 v100, v152, v144, s63
    v_perm_b32 v101, v156, v148, s63
    v_mfma_f32_16x16x32_bf16 v[40:43], v[96:99], v[92:95], v[40:43]
    v_perm_b32 v102, v154, v146, s63
    v_perm_b32 v103, v158, v150, s63
    v_perm_b32 v104, v153, v145, s62
    v_perm_b32 v105, v157, v149, s62
    v_mfma_f32_16x16x32_bf16 v[44:47], v[100:103], v[92:95], v[44:47]
    v_perm_b32 v106, v155, v147, s62
    v_perm_b32 v107, v159, v151, s62
    v_perm_b32 v108, v153, v145, s63
    v_perm_b32 v109, v157, v149, s63
    v_mfma_f32_16x16x32_bf16 v[48:51], v[104:107], v[92:95], v[48:51]
    v_perm_b32 v110, v155, v147, s63
    v_perm_b32 v111, v159, v151, s63
    s_cmp_eq_u32 s60, 16
    s_nop 0
    v_mfma_f32_16x16x32_bf16 v[52:55], v[108:111], v[92:95], v[52:55]
    s_nop 0
EPI:
    v_cvt_pk_bf16_f32 v72, v40, v44
    v_cvt_pk_bf16_f32 v74, v41, v45
    v_cvt_pk_bf16_f32 v76, v42, v46
    v_cvt_pk_bf16_f32 v78, v43, v47
    v_alignbit_b32 v82, v74, v74, 8
    v_alignbit_b32 v83, v78, v78, 8
    v_add3_u32 v80, v72, v82, v18
    v_add3_u32 v81, v76, v83, v19
    s_nop 1
    v_cvt_pk_bf16_f32 v73, v48, v52
    v_cvt_pk_bf16_f32 v75, v49, v53
    v_cvt_pk_bf16_f32 v77, v50, v54
    v_cvt_pk_bf16_f32 v79, v51, v55
    v_alignbit_b32 v82, v73, v73, 4
    v_alignbit_b32 v83, v75, v75, 12
    v_alignbit_b32 v84, v77, v77, 4
    v_alignbit_b32 v85, v79, v79, 12
    v_add3_u32 v80, v80, v82, v83
    v_add3_u32 v81, v81, v84, v85
    s_barrier
    buffer_store_dword v80, v12, s[36:39], s66 offen offset:1536 sc1
    buffer_store_dword v81, v12, s[36:39], s66 offen offset:3584 sc1
    buffer_store_dwordx4 v[72:75], v6, s[36:39], s66 offen offset:0 sc1
    buffer_store_dwordx4 v[76:79], v6, s[36:39], s66 offen offset:2048 sc1
CONSUME:
    s_cmp_ge_u32 s68, 13
    s_cbranch_scc1 CONS4
    s_cmp_ge_u32 s68, 9
    s_cbranch_scc1 CONS3
CONS2:
    buffer_load_dwordx4 v[128:131], v112, s[36:39], s67 offen sc1
    buffer_load_dword v144, v116, s[36:39], s67 offen sc1
    buffer_load_dwordx4 v[132:135], v113, s[36:39], s67 offen sc1
    buffer_load_dword v145, v117, s[36:39], s67 offen sc1
    ds_read_b128 v[32:35], v9
WAIT2:
    s_waitcnt vmcnt(3)
    v_alignbit_b32 v101, v129, v129, 4
    v_alignbit_b32 v102, v130, v130, 8
    v_alignbit_b32 v103, v131, v131, 12
    v_add3_u32 v100, v128, v101, v120
    v_lshlrev_b32 v104, 16, v128
    v_and_b32 v105, s54, v128
    v_add3_u32 v100, v100, v102, v103
    v_lshlrev_b32 v106, 16, v129
    v_and_b32 v107, s54, v129
    v_lshlrev_b32 v108, 16, v130
    v_and_b32 v109, s54, v130
    v_lshlrev_b32 v110, 16, v131
    v_and_b32 v111, s54, v131
    s_waitcnt vmcnt(2) lgkmcnt(0)
    v_xor_b32 v96, v100, v144
    v_pk_mul_f32 v[20:21], v[104:105], v[32:33] op_sel:[0,0] op_sel_hi:[1,0]
    v_pk_mul_f32 v[22:23], v[106:107], v[32:33] op_sel:[0,0] op_sel_hi:[1,0]
    v_pk_mul_f32 v[24:25], v[108:109], v[32:33] op_sel:[0,0] op_sel_hi:[1,0]
    v_pk_mul_f32 v[26:27], v[110:111], v[32:33] op_sel:[0,0] op_sel_hi:[1,0]
    s_waitcnt vmcnt(1)
    v_alignbit_b32 v101, v133, v133, 4
    v_alignbit_b32 v102, v134, v134, 8
    v_alignbit_b32 v103, v135, v135, 12
    v_add3_u32 v100, v132, v101, v121
    v_lshlrev_b32 v104, 16, v132
    v_and_b32 v105, s54, v132
    v_add3_u32 v100, v100, v102, v103
    v_lshlrev_b32 v106, 16, v133
    v_and_b32 v107, s54, v133
    v_lshlrev_b32 v108, 16, v134
    v_and_b32 v109, s54, v134
    v_lshlrev_b32 v110, 16, v135
    v_and_b32 v111, s54, v135
    s_waitcnt vmcnt(0)
    v_bitop3_b32 v96, v96, v100, v145 bitop3:0xf6
    v_pk_fma_f32 v[20:21], v[104:105], v[32:33], v[20:21] op_sel:[0,1,0] op_sel_hi:[1,1,1]
    v_pk_fma_f32 v[22:23], v[106:107], v[32:33], v[22:23] op_sel:[0,1,0] op_sel_hi:[1,1,1]
    v_pk_fma_f32 v[24:25], v[108:109], v[32:33], v[24:25] op_sel:[0,1,0] op_sel_hi:[1,1,1]
    v_pk_fma_f32 v[26:27], v[110:111], v[32:33], v[26:27] op_sel:[0,1,0] op_sel_hi:[1,1,1]
    v_cmp_ne_u32 vcc, 0, v96
    s_nop 0
    v_permlane32_swap_b32 v20, v24
    v_permlane32_swap_b32 v21, v25
    v_permlane32_swap_b32 v22, v26
    v_permlane32_swap_b32 v23, v27

    v_pk_add_f32 v[20:21], v[20:21], v[24:25]
    v_pk_add_f32 v[22:23], v[22:23], v[26:27]
    s_cbranch_vccnz RETRY2
    s_nop 0
    v_permlane16_swap_b32 v20, v22
    v_permlane16_swap_b32 v21, v23
    v_pk_add_f32 v[20:21], v[20:21], v[22:23]
    v_cvt_pk_bf16_f32 v20, v20, v21

    buffer_store_dword v20, v8, s[40:43], s73 offen
    s_endpgm
RETRY2:
    buffer_load_dwordx4 v[128:131], v112, s[36:39], s67 offen sc1
    buffer_load_dword v144, v116, s[36:39], s67 offen sc1
    buffer_load_dwordx4 v[132:135], v113, s[36:39], s67 offen sc1
    buffer_load_dword v145, v117, s[36:39], s67 offen sc1
    s_sub_u32 s72, s72, 1
    s_cbranch_scc0 WAIT2
    s_waitcnt vmcnt(0)
    s_endpgm
CONS3:
    buffer_load_dwordx4 v[128:131], v112, s[36:39], s67 offen sc1
    buffer_load_dword v144, v116, s[36:39], s67 offen sc1
    buffer_load_dwordx4 v[132:135], v113, s[36:39], s67 offen sc1
    buffer_load_dword v145, v117, s[36:39], s67 offen sc1
    buffer_load_dwordx4 v[136:139], v114, s[36:39], s67 offen sc1
    s_branch SKIP9
PAD9:
    s_branch PAD10
SKIP9:
    buffer_load_dword v146, v118, s[36:39], s67 offen sc1
    ds_read_b128 v[32:35], v9
WAIT3:
    s_waitcnt vmcnt(5)
    v_alignbit_b32 v101, v129, v129, 4
    v_alignbit_b32 v102, v130, v130, 8
    v_alignbit_b32 v103, v131, v131, 12
    v_add3_u32 v100, v128, v101, v120
    v_lshlrev_b32 v104, 16, v128
    v_and_b32 v105, s54, v128
    v_add3_u32 v100, v100, v102, v103
    v_lshlrev_b32 v106, 16, v129
    v_and_b32 v107, s54, v129
    v_lshlrev_b32 v108, 16, v130
    v_and_b32 v109, s54, v130
    v_lshlrev_b32 v110, 16, v131
    v_and_b32 v111, s54, v131
    s_waitcnt vmcnt(4) lgkmcnt(0)
    v_xor_b32 v96, v100, v144
    v_pk_mul_f32 v[20:21], v[104:105], v[32:33] op_sel:[0,0] op_sel_hi:[1,0]
    v_pk_mul_f32 v[22:23], v[106:107], v[32:33] op_sel:[0,0] op_sel_hi:[1,0]
    v_pk_mul_f32 v[24:25], v[108:109], v[32:33] op_sel:[0,0] op_sel_hi:[1,0]
    v_pk_mul_f32 v[26:27], v[110:111], v[32:33] op_sel:[0,0] op_sel_hi:[1,0]
    s_waitcnt vmcnt(3)
    v_alignbit_b32 v101, v133, v133, 4
    v_alignbit_b32 v102, v134, v134, 8
    v_alignbit_b32 v103, v135, v135, 12
    v_add3_u32 v100, v132, v101, v121
    v_lshlrev_b32 v104, 16, v132
    v_and_b32 v105, s54, v132
    v_add3_u32 v100, v100, v102, v103
    v_lshlrev_b32 v106, 16, v133
    v_and_b32 v107, s54, v133
    v_lshlrev_b32 v108, 16, v134
    v_and_b32 v109, s54, v134
    v_lshlrev_b32 v110, 16, v135
    v_and_b32 v111, s54, v135
    s_waitcnt vmcnt(2)
    v_bitop3_b32 v96, v96, v100, v145 bitop3:0xf6
    v_pk_fma_f32 v[20:21], v[104:105], v[32:33], v[20:21] op_sel:[0,1,0] op_sel_hi:[1,1,1]
    v_pk_fma_f32 v[22:23], v[106:107], v[32:33], v[22:23] op_sel:[0,1,0] op_sel_hi:[1,1,1]
    v_pk_fma_f32 v[24:25], v[108:109], v[32:33], v[24:25] op_sel:[0,1,0] op_sel_hi:[1,1,1]
    v_pk_fma_f32 v[26:27], v[110:111], v[32:33], v[26:27] op_sel:[0,1,0] op_sel_hi:[1,1,1]
    s_waitcnt vmcnt(1)
    v_alignbit_b32 v101, v137, v137, 4
    v_alignbit_b32 v102, v138, v138, 8
    v_alignbit_b32 v103, v139, v139, 12
    v_add3_u32 v100, v136, v101, v122
    v_lshlrev_b32 v104, 16, v136
    v_and_b32 v105, s54, v136
    v_add3_u32 v100, v100, v102, v103
    v_lshlrev_b32 v106, 16, v137
    v_and_b32 v107, s54, v137
    v_lshlrev_b32 v108, 16, v138
    v_and_b32 v109, s54, v138
    v_lshlrev_b32 v110, 16, v139
    v_and_b32 v111, s54, v139
    s_waitcnt vmcnt(0)
    v_bitop3_b32 v96, v96, v100, v146 bitop3:0xf6
    v_pk_fma_f32 v[20:21], v[104:105], v[34:35], v[20:21] op_sel:[0,0,0] op_sel_hi:[1,0,1]
    v_pk_fma_f32 v[22:23], v[106:107], v[34:35], v[22:23] op_sel:[0,0,0] op_sel_hi:[1,0,1]
    v_pk_fma_f32 v[24:25], v[108:109], v[34:35], v[24:25] op_sel:[0,0,0] op_sel_hi:[1,0,1]
    v_pk_fma_f32 v[26:27], v[110:111], v[34:35], v[26:27] op_sel:[0,0,0] op_sel_hi:[1,0,1]
    v_cmp_ne_u32 vcc, 0, v96
    s_nop 0
    v_permlane32_swap_b32 v20, v24
    v_permlane32_swap_b32 v21, v25
    v_permlane32_swap_b32 v22, v26
    v_permlane32_swap_b32 v23, v27

    v_pk_add_f32 v[20:21], v[20:21], v[24:25]
    v_pk_add_f32 v[22:23], v[22:23], v[26:27]
    s_cbranch_vccnz RETRY3
    s_nop 0
    v_permlane16_swap_b32 v20, v22
    v_permlane16_swap_b32 v21, v23
    v_pk_add_f32 v[20:21], v[20:21], v[22:23]
    v_cvt_pk_bf16_f32 v20, v20, v21

    buffer_store_dword v20, v8, s[40:43], s73 offen
    s_endpgm
RETRY3:
    buffer_load_dwordx4 v[128:131], v112, s[36:39], s67 offen sc1
    buffer_load_dword v144, v116, s[36:39], s67 offen sc1
    buffer_load_dwordx4 v[132:135], v113, s[36:39], s67 offen sc1
    buffer_load_dword v145, v117, s[36:39], s67 offen sc1
    buffer_load_dwordx4 v[136:139], v114, s[36:39], s67 offen sc1
    buffer_load_dword v146, v118, s[36:39], s67 offen sc1
    s_sub_u32 s72, s72, 1
    s_cbranch_scc0 WAIT3
    s_waitcnt vmcnt(0)
    s_endpgm
CONS4:
    buffer_load_dwordx4 v[128:131], v112, s[36:39], s67 offen sc1
    buffer_load_dword v144, v116, s[36:39], s67 offen sc1
    buffer_load_dwordx4 v[132:135], v113, s[36:39], s67 offen sc1
    buffer_load_dword v145, v117, s[36:39], s67 offen sc1
    buffer_load_dwordx4 v[136:139], v114, s[36:39], s67 offen sc1
    buffer_load_dword v146, v118, s[36:39], s67 offen sc1
    buffer_load_dwordx4 v[140:143], v115, s[36:39], s67 offen sc1
    buffer_load_dword v147, v119, s[36:39], s67 offen sc1
    ds_read_b128 v[32:35], v9
WAIT4:
    s_waitcnt vmcnt(7)
    v_alignbit_b32 v101, v129, v129, 4
    v_alignbit_b32 v102, v130, v130, 8
    v_alignbit_b32 v103, v131, v131, 12
    v_add3_u32 v100, v128, v101, v120
    v_lshlrev_b32 v104, 16, v128
    v_and_b32 v105, s54, v128
    v_add3_u32 v100, v100, v102, v103
    v_lshlrev_b32 v106, 16, v129
    v_and_b32 v107, s54, v129
    v_lshlrev_b32 v108, 16, v130
    v_and_b32 v109, s54, v130
    v_lshlrev_b32 v110, 16, v131
    v_and_b32 v111, s54, v131
    s_waitcnt vmcnt(6) lgkmcnt(0)
    v_xor_b32 v96, v100, v144
    v_pk_mul_f32 v[20:21], v[104:105], v[32:33] op_sel:[0,0] op_sel_hi:[1,0]
    v_pk_mul_f32 v[22:23], v[106:107], v[32:33] op_sel:[0,0] op_sel_hi:[1,0]
    v_pk_mul_f32 v[24:25], v[108:109], v[32:33] op_sel:[0,0] op_sel_hi:[1,0]
    v_pk_mul_f32 v[26:27], v[110:111], v[32:33] op_sel:[0,0] op_sel_hi:[1,0]
    s_waitcnt vmcnt(5)
    v_alignbit_b32 v101, v133, v133, 4
    v_alignbit_b32 v102, v134, v134, 8
    v_alignbit_b32 v103, v135, v135, 12
    v_add3_u32 v100, v132, v101, v121
    v_lshlrev_b32 v104, 16, v132
    v_and_b32 v105, s54, v132
    v_add3_u32 v100, v100, v102, v103
    v_lshlrev_b32 v106, 16, v133
    v_and_b32 v107, s54, v133
    v_lshlrev_b32 v108, 16, v134
    v_and_b32 v109, s54, v134
    v_lshlrev_b32 v110, 16, v135
    v_and_b32 v111, s54, v135
    s_waitcnt vmcnt(4)
    v_bitop3_b32 v96, v96, v100, v145 bitop3:0xf6
    v_pk_fma_f32 v[20:21], v[104:105], v[32:33], v[20:21] op_sel:[0,1,0] op_sel_hi:[1,1,1]
    v_pk_fma_f32 v[22:23], v[106:107], v[32:33], v[22:23] op_sel:[0,1,0] op_sel_hi:[1,1,1]
    v_pk_fma_f32 v[24:25], v[108:109], v[32:33], v[24:25] op_sel:[0,1,0] op_sel_hi:[1,1,1]
    v_pk_fma_f32 v[26:27], v[110:111], v[32:33], v[26:27] op_sel:[0,1,0] op_sel_hi:[1,1,1]
    s_waitcnt vmcnt(3)
    v_alignbit_b32 v101, v137, v137, 4
    v_alignbit_b32 v102, v138, v138, 8
    v_alignbit_b32 v103, v139, v139, 12
    v_add3_u32 v100, v136, v101, v122
    v_lshlrev_b32 v104, 16, v136
    v_and_b32 v105, s54, v136
    v_add3_u32 v100, v100, v102, v103
    v_lshlrev_b32 v106, 16, v137
    v_and_b32 v107, s54, v137
    v_lshlrev_b32 v108, 16, v138
    v_and_b32 v109, s54, v138
    v_lshlrev_b32 v110, 16, v139
    v_and_b32 v111, s54, v139
    s_waitcnt vmcnt(2)
    v_bitop3_b32 v96, v96, v100, v146 bitop3:0xf6
    v_pk_fma_f32 v[20:21], v[104:105], v[34:35], v[20:21] op_sel:[0,0,0] op_sel_hi:[1,0,1]
    v_pk_fma_f32 v[22:23], v[106:107], v[34:35], v[22:23] op_sel:[0,0,0] op_sel_hi:[1,0,1]
    v_pk_fma_f32 v[24:25], v[108:109], v[34:35], v[24:25] op_sel:[0,0,0] op_sel_hi:[1,0,1]
    v_pk_fma_f32 v[26:27], v[110:111], v[34:35], v[26:27] op_sel:[0,0,0] op_sel_hi:[1,0,1]
    s_waitcnt vmcnt(1)
    v_alignbit_b32 v101, v141, v141, 4
    v_alignbit_b32 v102, v142, v142, 8
    v_alignbit_b32 v103, v143, v143, 12
    v_add3_u32 v100, v140, v101, v123
    v_lshlrev_b32 v104, 16, v140
    v_and_b32 v105, s54, v140
    v_add3_u32 v100, v100, v102, v103
    v_lshlrev_b32 v106, 16, v141
    v_and_b32 v107, s54, v141
    v_lshlrev_b32 v108, 16, v142
    s_branch SKIP10
PAD10:
    s_branch HELPER
SKIP10:
    v_and_b32 v109, s54, v142
    v_lshlrev_b32 v110, 16, v143
    v_and_b32 v111, s54, v143
    s_waitcnt vmcnt(0)
    v_bitop3_b32 v96, v96, v100, v147 bitop3:0xf6
    v_pk_fma_f32 v[20:21], v[104:105], v[34:35], v[20:21] op_sel:[0,1,0] op_sel_hi:[1,1,1]
    v_pk_fma_f32 v[22:23], v[106:107], v[34:35], v[22:23] op_sel:[0,1,0] op_sel_hi:[1,1,1]
    v_pk_fma_f32 v[24:25], v[108:109], v[34:35], v[24:25] op_sel:[0,1,0] op_sel_hi:[1,1,1]
    v_pk_fma_f32 v[26:27], v[110:111], v[34:35], v[26:27] op_sel:[0,1,0] op_sel_hi:[1,1,1]
    v_cmp_ne_u32 vcc, 0, v96
    s_nop 0
    v_permlane32_swap_b32 v20, v24
    v_permlane32_swap_b32 v21, v25
    v_permlane32_swap_b32 v22, v26
    v_permlane32_swap_b32 v23, v27

    v_pk_add_f32 v[20:21], v[20:21], v[24:25]
    v_pk_add_f32 v[22:23], v[22:23], v[26:27]
    s_cbranch_vccnz RETRY4
    s_nop 0
    v_permlane16_swap_b32 v20, v22
    v_permlane16_swap_b32 v21, v23
    v_pk_add_f32 v[20:21], v[20:21], v[22:23]
    v_cvt_pk_bf16_f32 v20, v20, v21

    buffer_store_dword v20, v8, s[40:43], s73 offen
    s_endpgm
RETRY4:
    buffer_load_dwordx4 v[128:131], v112, s[36:39], s67 offen sc1
    buffer_load_dword v144, v116, s[36:39], s67 offen sc1
    buffer_load_dwordx4 v[132:135], v113, s[36:39], s67 offen sc1
    buffer_load_dword v145, v117, s[36:39], s67 offen sc1
    buffer_load_dwordx4 v[136:139], v114, s[36:39], s67 offen sc1
    buffer_load_dword v146, v118, s[36:39], s67 offen sc1
    buffer_load_dwordx4 v[140:143], v115, s[36:39], s67 offen sc1
    buffer_load_dword v147, v119, s[36:39], s67 offen sc1
    s_sub_u32 s72, s72, 1
    s_cbranch_scc0 WAIT4
    s_waitcnt vmcnt(0)
    s_endpgm
DONE:
    s_endpgm
IDLE:
    s_waitcnt vmcnt(0)
    s_barrier
    s_branch CONSUME
DONE0:
    s_waitcnt lgkmcnt(0)
    s_endpgm
KZERO:
    s_waitcnt vmcnt(0)
    s_branch KEND
SLOW:
    s_waitcnt vmcnt(0) lgkmcnt(0)
    v_mov_b32 v30, v31

    v_mov_b32 v96, 7282
    v_mov_b32 v97, 6554
    v_mov_b32 v98, 5958
    v_mov_b32 v99, 5462
    s_mov_b32 exec_lo, 0
    v_mov_b32 v96, 5042
    v_mov_b32 v97, 4682
    v_mov_b32 v98, 4370
    v_mov_b32 v99, 4096
    s_mov_b32 exec_lo, -1
    s_mov_b32 s63, 0x07060302
    s_mov_b32 s70, 0x10000

    v_add_u32 v106, -1, v31
    v_min_u32 v106, 0x7ff, v106
    v_lshrrev_b32 v107, 4, v106
    v_mad_u32_u24 v96, v107, v96, s70
    v_mad_u32_u24 v97, v107, v97, s70
    v_mad_u32_u24 v98, v107, v98, s70
    v_mad_u32_u24 v99, v107, v99, s70
    v_perm_b32 v100, v97, v96, s63
    v_perm_b32 v101, v99, v98, s63
    v_cmp_lt_i32 s[76:77], 0, v31
    v_add_u32_dpp v102, v100, v100 row_shr:1 row_mask:0xf bank_mask:0xf bound_ctrl:0
    v_add_u32_dpp v103, v101, v101 row_shr:1 row_mask:0xf bank_mask:0xf bound_ctrl:0

    s_nop 0
    v_add_u32_dpp v102, v102, v102 row_shr:2 row_mask:0xf bank_mask:0xf bound_ctrl:0
    v_add_u32_dpp v103, v103, v103 row_shr:2 row_mask:0xf bank_mask:0xf bound_ctrl:0

    s_nop 0
    v_add_u32_dpp v102, v102, v102 row_shr:4 row_mask:0xf bank_mask:0xf bound_ctrl:0
    v_add_u32_dpp v103, v103, v103 row_shr:4 row_mask:0xf bank_mask:0xf bound_ctrl:0

    s_nop 0
    v_add_u32_dpp v102, v102, v102 row_shr:8 row_mask:0xf bank_mask:0xf bound_ctrl:0
    v_add_u32_dpp v103, v103, v103 row_shr:8 row_mask:0xf bank_mask:0xf bound_ctrl:0

    s_nop 0
    v_add_u32_dpp v102, v102, v102 row_bcast:15 row_mask:0xa bank_mask:0xf
    v_add_u32_dpp v103, v103, v103 row_bcast:15 row_mask:0xa bank_mask:0xf
    v_add_u32 v96, 0x00ff00ff, v102
    v_add_u32 v97, 0x00ff00ff, v103
    v_and_b32 v96, 0x02000200, v96
    v_and_b32 v97, 0x02000200, v97
    v_lshl_or_b32 v96, v97, 1, v96
    s_nop 0
    v_readlane_b32 s78, v96, 31
    v_readlane_b32 s79, v96, 63
    s_bcnt1_i32_b64 s70, s[78:79]
    s_bitcmp1_b32 s70, 1
    s_cselect_b64 vcc, -1, 0
    s_and_b32 s71, s70, 1
    s_lshl_b32 s71, s71, 4
    v_cndmask_b32 v102, v102, v103, vcc
    v_cndmask_b32 v100, v100, v101, vcc
    v_bfe_u32 v102, v102, s71, 16
    v_bfe_u32 v100, v100, s71, 16
    v_cmp_lt_u32 vcc, s2, v102
    v_sub_u32 v12, v102, v100
    v_lshl_or_b32 v12, v100, 10, v12
    v_lshl_or_b32 v12, v106, 16, v12
    s_and_b32 s69, s70, 4
    s_lshl_b32 s69, s69, 3

    s_lshr_b32 s70, s75, 3
    s_add_u32 s71, s70, s69
    v_readlane_b32 s68, v12, s71
    s_bfe_u32 s68, s68, 0x5000a

    s_lshr_b64 s[78:79], vcc, s69
    s_ff1_i32_b32 s57, s78
    s_add_u32 s70, s57, s69
    v_readlane_b32 s70, v12, s70
    s_bfe_u32 s58, s70, 0x5000a
    s_and_b32 s71, s70, 0x3ff
    s_lshr_b32 s59, s70, 16
    s_sub_u32 s32, s2, s71
    s_add_u32 s59, s59, 1
    s_cmp_lt_i32 s57, 0
    s_cselect_b32 s59, 0, s59
    s_cselect_b32 s32, 0, s32
    s_and_b32 s57, s57, 31
    s_bitcmp1_b32 s76, s57
    s_cselect_b32 s30, 0x40000, 0
    s_cselect_b32 s22, 0x4010000, 0

    s_lshl_b32 s47, s57, 7
    s_add_u32 s70, s47, s32
    v_mul_i32_i24 v26, s58, v21

    v_add_u32 v26, s70, v26

    v_min_u32 v22, 0xfff, v26
    v_lshlrev_b32 v22, 2, v22

    global_load_dword v13, v22, s[10:11]
    s_branch COMMON
HELPER:

    v_and_b32 v1, 63, v0
    v_and_b32 v28, 15, v0
    v_lshrrev_b32 v29, 4, v1
    v_and_b32 v20, 31, v0
    v_lshlrev_b32 v6, 2, v20
    v_mov_b32 v11, 0x40000000
    v_mov_b32 v10, 0xff000000

    s_and_b32 s70, s2, 3
    s_mov_b32 s44, 0x81631a8
    s_mov_b32 s45, 0x62929ea
    s_cmp_eq_u32 s70, 1
    s_cmov_b32 s44, 0x2ce913b6
    s_cmov_b32 s45, 0x23380ac8
    s_cmp_eq_u32 s70, 2
    s_cmov_b32 s44, 0xd2a2086
    s_cmov_b32 s45, 0x3e082aa7
    s_cmp_eq_u32 s70, 3
    s_cmov_b32 s44, 0x32ba0fd7
    s_cmov_b32 s45, 0x1b7a1fc9
    s_and_b32 s35, s2, 12
    s_lshl_b32 s35, s35, 2

    s_lshr_b32 s46, s2, 4
    s_xor_b32 s70, s35, 16
    s_lshr_b64 s[78:79], s[44:45], s70
    s_and_b32 s68, s78, 15
    s_sub_u32 s71, 16, s68
    s_cmp_lt_u32 s46, 8
    s_cselect_b32 s70, 4, 9
    s_cselect_b32 s68, s68, s71
    s_lshr_b32 s75, s78, s70
    s_and_b32 s75, s75, 31
    s_lshl_b32 s34, s75, 5
    s_and_b32 s70, s46, 7
    s_lshl3_add_u32 s75, s75, s70
    s_and_b32 s70, s46, 3
    s_lshl3_add_u32 s34, s70, s34
    s_and_b32 s70, s46, 4
    s_or_b32 s34, s34, s70

    s_movk_i32 s70, 433
    v_mad_u32_u24 v30, v20, s70, s70
    v_and_b32 v30, 0x3ff, v30
    v_sub_u32 v30, 0x800, v30

    s_waitcnt lgkmcnt(0)
    global_load_dword v31, v6, s[12:13]
    s_load_dword s3, s[18:19], s34

    s_mov_b32 s36, s18
    s_mov_b32 s37, s19
    s_mov_b32 s38, 0x10040000
    s_mov_b32 s39, 0x00020000

    v_cmp_eq_u32 vcc, 0, v1
    s_mov_b32 s72, 65536
    s_bitcmp1_b32 s75, 2
    s_cselect_b64 s[80:81], -1, 0
    v_cndmask_b32 v2, v11, v1, vcc
    s_waitcnt vmcnt(0) lgkmcnt(0)
    v_cmp_ne_u32 vcc, v31, v30
    s_cbranch_vccnz H_SLOW

H_GO:

    s_lshr_b32 s70, s75, 3
    s_mul_i32 s70, s70, 278528
    s_add_u32 s70, s70, 4096

    s_add_u32 s3, s3, 0x1010101
    v_mov_b32 v18, s3
    s_and_b32 s71, s75, 3
    s_lshl_b32 s71, s71, 7
    s_add_u32 s67, s70, s71
    s_add_u32 s67, s67, 16896
    s_movk_i32 s70, 17408
    v_cmp_gt_u32 s[78:79], s68, v28
    v_mul_u32_u24 v4, s70, v28
    v_lshl_add_u32 v4, v29, 4, v4
    v_cndmask_b32 v4, v11, v4, s[78:79]
    v_cndmask_b32 v5, 0, v18, s[78:79]
    v_and_b32 v20, 3, v28
    v_lshlrev_b32 v9, 4, v20
    v_lshrrev_b32 v20, 2, v28
    v_lshl_add_u32 v9, v20, 2, v9

    v_lshl_add_u32 v9, v29, 6, v9

H_POLL:

    s_sub_u32 s72, s72, 1
    s_cbranch_scc1 DONE
    s_sleep 24
    buffer_load_dwordx4 v[128:131], v4, s[36:39], s67 offen sc1
    buffer_load_dwordx4 v[132:135], v4, s[36:39], s67 offen offset:64 sc1
    s_waitcnt vmcnt(0)
    v_cndmask_b32 v130, v130, v131, s[80:81]
    v_cndmask_b32 v134, v134, v135, s[80:81]
    v_xor_b32 v20, v130, v5
    v_bitop3_b32 v20, v20, v134, v5 bitop3:0xf6
    v_cmp_ne_u32 vcc, 0, v20
    s_cbranch_vccnz H_POLL
    v_cndmask_b32 v128, v10, v128, s[78:79]
    v_cndmask_b32 v132, v10, v132, s[78:79]

    s_nop 0
    v_max_f32_dpp v20, v128, v128 row_ror:8 row_mask:0xf bank_mask:0xf
    v_max_f32_dpp v21, v132, v132 row_ror:8 row_mask:0xf bank_mask:0xf
    s_nop 0
    v_max_f32_dpp v20, v20, v20 row_ror:4 row_mask:0xf bank_mask:0xf
    v_max_f32_dpp v21, v21, v21 row_ror:4 row_mask:0xf bank_mask:0xf
    s_nop 0
    v_max_f32_dpp v20, v20, v20 row_ror:2 row_mask:0xf bank_mask:0xf
    v_max_f32_dpp v21, v21, v21 row_ror:2 row_mask:0xf bank_mask:0xf
    s_nop 0
    v_max_f32_dpp v20, v20, v20 row_ror:1 row_mask:0xf bank_mask:0xf
    v_max_f32_dpp v21, v21, v21 row_ror:1 row_mask:0xf bank_mask:0xf

    v_sub_f32 v128, v128, v20
    v_sub_f32 v132, v132, v21
    v_exp_f32 v128, v128
    v_exp_f32 v132, v132
    s_nop 0
    v_mul_f32 v129, v129, v128
    v_mul_f32 v133, v133, v132

    s_nop 0
    v_add_f32_dpp v20, v129, v129 row_ror:8 row_mask:0xf bank_mask:0xf
    v_add_f32_dpp v21, v133, v133 row_ror:8 row_mask:0xf bank_mask:0xf
    s_nop 0
    v_add_f32_dpp v20, v20, v20 row_ror:4 row_mask:0xf bank_mask:0xf
    v_add_f32_dpp v21, v21, v21 row_ror:4 row_mask:0xf bank_mask:0xf
    s_nop 0
    v_add_f32_dpp v20, v20, v20 row_ror:2 row_mask:0xf bank_mask:0xf
    v_add_f32_dpp v21, v21, v21 row_ror:2 row_mask:0xf bank_mask:0xf
    s_nop 0
    v_add_f32_dpp v20, v20, v20 row_ror:1 row_mask:0xf bank_mask:0xf
    v_add_f32_dpp v21, v21, v21 row_ror:1 row_mask:0xf bank_mask:0xf

    v_rcp_f32 v20, v20
    v_rcp_f32 v21, v21
    s_nop 0
    v_mul_f32 v128, v128, v20
    v_mul_f32 v132, v132, v21
    ds_write_b32 v9, v128
    ds_write_b32 v9, v132 offset:256
    s_waitcnt lgkmcnt(0)
    s_barrier

    buffer_store_dword v18, v2, s[36:39], s34 offen
    s_endpgm
H_SLOW:

    v_mov_b32 v96, 7282
    v_mov_b32 v97, 6554
    v_mov_b32 v98, 5958
    v_mov_b32 v99, 5462
    s_mov_b32 exec_lo, 0
    v_mov_b32 v96, 5042
    v_mov_b32 v97, 4682
    v_mov_b32 v98, 4370
    v_mov_b32 v99, 4096
    s_mov_b32 exec_lo, -1
    s_mov_b32 s63, 0x07060302
    s_mov_b32 s70, 0x10000

    v_add_u32 v106, -1, v31
    v_min_u32 v106, 0x7ff, v106
    v_lshrrev_b32 v107, 4, v106
    v_mad_u32_u24 v96, v107, v96, s70
    v_mad_u32_u24 v97, v107, v97, s70
    v_mad_u32_u24 v98, v107, v98, s70
    v_mad_u32_u24 v99, v107, v99, s70
    v_perm_b32 v100, v97, v96, s63
    v_perm_b32 v101, v99, v98, s63
    v_cmp_lt_i32 s[76:77], 0, v31
    v_add_u32_dpp v102, v100, v100 row_shr:1 row_mask:0xf bank_mask:0xf bound_ctrl:0
    v_add_u32_dpp v103, v101, v101 row_shr:1 row_mask:0xf bank_mask:0xf bound_ctrl:0

    s_nop 0
    v_add_u32_dpp v102, v102, v102 row_shr:2 row_mask:0xf bank_mask:0xf bound_ctrl:0
    v_add_u32_dpp v103, v103, v103 row_shr:2 row_mask:0xf bank_mask:0xf bound_ctrl:0

    s_nop 0
    v_add_u32_dpp v102, v102, v102 row_shr:4 row_mask:0xf bank_mask:0xf bound_ctrl:0
    v_add_u32_dpp v103, v103, v103 row_shr:4 row_mask:0xf bank_mask:0xf bound_ctrl:0

    s_nop 0
    v_add_u32_dpp v102, v102, v102 row_shr:8 row_mask:0xf bank_mask:0xf bound_ctrl:0
    v_add_u32_dpp v103, v103, v103 row_shr:8 row_mask:0xf bank_mask:0xf bound_ctrl:0

    s_nop 0
    v_add_u32_dpp v102, v102, v102 row_bcast:15 row_mask:0xa bank_mask:0xf
    v_add_u32_dpp v103, v103, v103 row_bcast:15 row_mask:0xa bank_mask:0xf
    v_add_u32 v96, 0x00ff00ff, v102
    v_add_u32 v97, 0x00ff00ff, v103
    v_and_b32 v96, 0x02000200, v96
    v_and_b32 v97, 0x02000200, v97
    v_lshl_or_b32 v96, v97, 1, v96
    s_nop 0
    v_readlane_b32 s78, v96, 31
    v_readlane_b32 s79, v96, 63
    s_bcnt1_i32_b64 s70, s[78:79]
    s_bitcmp1_b32 s70, 1
    s_cselect_b64 vcc, -1, 0
    s_and_b32 s71, s70, 1
    s_lshl_b32 s71, s71, 4
    v_cndmask_b32 v102, v102, v103, vcc
    v_cndmask_b32 v100, v100, v101, vcc
    v_bfe_u32 v102, v102, s71, 16
    v_bfe_u32 v100, v100, s71, 16
    v_cmp_lt_u32 vcc, s2, v102
    v_sub_u32 v12, v102, v100
    v_lshl_or_b32 v12, v100, 10, v12
    v_lshl_or_b32 v12, v106, 16, v12
    s_and_b32 s69, s70, 4
    s_lshl_b32 s69, s69, 3

    s_lshr_b32 s70, s75, 3
    s_add_u32 s71, s70, s69
    v_readlane_b32 s68, v12, s71
    s_bfe_u32 s68, s68, 0x5000a

    s_branch H_GO
.section .rodata,"a"
.p2align 6
.amdhsa_kernel standalone__paged_block_table_kv_pagedattention__sampling_kernel
  .amdhsa_next_free_vgpr 224
  .amdhsa_next_free_sgpr 102
  .amdhsa_accum_offset 224
  .amdhsa_group_segment_fixed_size 0
  .amdhsa_kernarg_size 64
  .amdhsa_user_sgpr_count 2
  .amdhsa_user_sgpr_kernarg_segment_ptr 1
  .amdhsa_system_sgpr_workgroup_id_x 1
.end_amdhsa_kernel
```
